```python
import torch

def _softmax(x, axis=-1):
    return torch.softmax(x, dim=axis)
def _gelu(x):
    return torch.nn.functional.gelu(x, approximate="tanh")
def _silu(x):
    return torch.nn.functional.silu(x)
def _sigmoid(x):
    return torch.sigmoid(x)
def _layernorm(x, axis=-1, eps=1e-5):
    m = x.mean(dim=axis, keepdim=True)
    v = x.var(dim=axis, keepdim=True, unbiased=False)
    return (x - m) / torch.sqrt(v + eps)
def _scatter_add(tgt, idx, src, axis=0):
    return tgt.clone().index_add_(axis, idx, src)
def _segment_sum(src, seg, n):
    out = torch.zeros((n,) + src.shape[1:], dtype=src.dtype)
    return out.index_add_(0, seg, src)
def _pad(x, pw):
    flat = tuple(v for pair in reversed(pw) for v in pair)
    return torch.nn.functional.pad(x, flat)

kernel_name = 'concat_heads__sliding_local_dilated__softmax_full_mha__prompt'

def setup_inputs():

    _w = (lambda a: (lambda t: t.to(torch.bfloat16) if t.is_floating_point() else t)(torch.as_tensor(a)))
    def _A_setup():
        B, S, D = 1, 2048, 512
        return {
            "x": _w((lambda *s: torch.randn(*s, dtype=torch.bfloat16) * 0.4)(B, S, D)),
            "wqkv": _w((lambda *s: torch.randn(*s, dtype=torch.bfloat16) * 0.4)(D, 3 * D)),
            "wo": _w((lambda *s: torch.randn(*s, dtype=torch.bfloat16) * 0.05)(D, D)),
        }
    _A_in = _A_setup()

    def _B_setup():
        B, S, D = 1, 2048, 512
        return {
            "x": _w((lambda *s: torch.randn(*s, dtype=torch.bfloat16) * 0.2)(B, S, D)),
            "wqkv": _w((lambda *s: torch.randn(*s, dtype=torch.bfloat16) * 0.4)(D, 3 * D)),
            "wo": _w((lambda *s: torch.randn(*s, dtype=torch.bfloat16) * 0.1)(D, D)),
        }
    _B_in = _B_setup()

    return {
        "A_x": _A_in["x"],
        "A_wqkv": _A_in["wqkv"],
        "A_wo": _A_in["wo"],
        "B_x": _B_in["x"],
        "B_wqkv": _B_in["wqkv"],
        "B_wo": _B_in["wo"],
    }

def reference(A_x, A_wqkv, A_wo, B_x, B_wqkv, B_wo):
    def _A_ref(x, wqkv, wo):
        B, S, D = x.shape
        H = 32; Dh = D // H
        W, dil = 8, 2
        qkv = (lambda x, *d: x.permute(*d))((x @ wqkv).reshape(B, S, 3, H, Dh), 2, 0, 3, 1, 4)
        q, k, v = qkv[0], qkv[1], qkv[2]
        scale = Dh ** -0.5
        pos = torch.arange(S)
        off = torch.arange(W) * dil
        idx = pos[:, None] - off[None, :]
        mask = idx >= 0
        idx_c = torch.where(mask, idx, 0).reshape(-1)
        kg = k[:, :, idx_c, :].reshape(B, H, S, W, Dh)
        vg = v[:, :, idx_c, :].reshape(B, H, S, W, Dh)
        logits = torch.einsum("bhsd,bhswd->bhsw", q, kg) * scale
        logits = torch.where(mask[None, None, :, :], logits, -1e9)
        attn = _softmax(logits, axis=-1)
        o = torch.einsum("bhsw,bhswd->bhsd", attn, vg)
        return (lambda x, *d: x.permute(*d))(o, 0, 2, 1, 3).reshape(B, S, D) @ wo

    def _B_ref(x, wqkv, wo):
        B, S, D = x.shape
        H = 32; Dh = D // H
        qkv = (lambda x, *d: x.permute(*d))((x @ wqkv).reshape(B, S, 3, H, Dh), 2, 0, 3, 1, 4)
        q, k, v = qkv[0], qkv[1], qkv[2]
        scale = Dh ** -0.5
        scores = torch.einsum("bhqd,bhkd->bhqk", q, k) * scale
        p = _softmax(scores, axis=-1)
        o = torch.einsum("bhqk,bhkd->bhqd", p, v)
        return (lambda x, *d: x.permute(*d))(o, 0, 2, 1, 3).reshape(B, S, D) @ wo

    a = _A_ref(A_x, A_wqkv, A_wo)
    b = _B_ref(B_x, B_wqkv, B_wo)
    return torch.concatenate([a, b], axis=-1)
```

```asm
; @launch grid=(256,1,1) block=(768,1,1) lds=163840
.amdgcn_target "amdgcn-amd-amdhsa--gfx950"
.text
.globl concat_heads__sliding_local_dilated__softmax_full_mha__prompt_kernel
.p2align 8
.type concat_heads__sliding_local_dilated__softmax_full_mha__prompt_kernel,@function
concat_heads__sliding_local_dilated__softmax_full_mha__prompt_kernel:
    s_cmp_ge_u32 s2, 256
    s_cbranch_scc1 L_end
    s_load_dwordx16 s[4:19], s[0:1], 0
    s_load_dwordx2 s[20:21], s[0:1], 64
    v_lshrrev_b32 v1, 6, v0
    v_and_b32 v0, 63, v0
    s_lshr_b32 s43, s2, 3
    v_readfirstlane_b32 s22, v1
    s_and_b32 s23, s2, 1
    s_lshl_b32 s23, s23, 2
    s_and_b32 s42, s43, 3
    s_add_u32 s23, s23, s42
    s_and_b32 s24, s2, 6
    s_lshl_b32 s24, s24, 2
    s_lshr_b32 s42, s43, 2
    s_add_u32 s24, s24, s42
    s_and_b32 s26, s24, 1
    s_lshr_b32 s27, s24, 1
    s_lshl_b32 s25, s23, 1
    s_add_u32 s25, s25, s27
    s_and_b32 s42, s23, 4
    s_cmp_eq_u32 s26, 0
    s_cselect_b32 s40, 1, 0
    s_cselect_b32 s41, 2, 0
    s_add_u32 s40, s40, s23
    s_and_b32 s40, s40, 3
    s_or_b32 s40, s40, s42
    s_add_u32 s41, s41, s23
    s_and_b32 s41, s41, 3
    s_or_b32 s41, s41, s42
    s_mov_b32 s3, s23
    s_cmp_lg_u32 s23, 3
    s_cselect_b32 s42, s26, 0
    s_cmp_ge_u32 s22, 8
    s_cbranch_scc1 L_aux
    v_lshrrev_b32 v4, 3, v0
    v_mul_u32_u24 v3, 3072, v4
    v_lshlrev_b32 v4, 10, v4
    v_lshrrev_b32 v5, 2, v0
    v_and_b32 v5, 4, v5
    v_xor_b32 v5, v5, v0
    v_and_b32 v5, 7, v5
    v_lshl_add_u32 v3, v5, 4, v3
    v_lshrrev_b32 v5, 4, v0
    v_xor_b32 v5, v5, v0
    v_and_b32 v5, 7, v5
    v_lshl_add_u32 v2, v5, 4, v4
    v_xor_b32 v17, 64, v2
    v_add_u32 v17, 8192, v17
    s_lshl_b32 s60, s27, 17
    s_lshl_b32 s68, s22, 14
    s_add_u32 s60, s60, s68
    s_lshl_b32 s61, s22, 10
    s_lshl_b32 s73, s22, 11
    s_mul_i32 s62, s22, 24576
    s_lshl_b32 s68, s40, 7
    s_add_u32 s93, s62, s68
    s_lshl_b32 s68, s41, 7
    s_add_u32 s94, s62, s68
    s_lshl_b32 s68, s3, 7
    s_add_u32 s62, s62, s68
    s_mov_b32 s30, 2097152
    s_mov_b32 s31, 0x00020000
    s_mov_b32 s34, 1572864
    s_mov_b32 s35, 0x00020000
    s_cmp_eq_u32 s26, 0
    s_waitcnt lgkmcnt(0)
    s_cselect_b32 s28, s10, s4
    s_cselect_b32 s29, s11, s5
    s_cselect_b32 s32, s12, s6
    s_cselect_b32 s33, s13, s7
    s_mov_b32 s68, 0
    s_mul_i32 s69, s68, 196608
    s_lshl_b32 s68, s68, 7
    s_add_u32 m0, s73, 65536
    s_add_u32 s68, s68, s60
    buffer_load_dwordx4 v2, s[28:31], s68 offen lds
    s_add_u32 m0, s61, 48128
    s_add_u32 s70, s69, s93
    buffer_load_dwordx4 v3, s[32:35], s70 offen offset:1024 lds
    s_add_u32 m0, s73, 66560
    s_nop 0
    buffer_load_dwordx4 v17, s[28:31], s68 offen lds
    s_add_u32 m0, s61, 55296
    s_add_u32 s70, s69, s94
    buffer_load_dwordx4 v3, s[32:35], s70 offen offset:2048 lds
    s_add_u32 m0, s61, 40960
    s_add_u32 s70, s69, s62
    buffer_load_dwordx4 v3, s[32:35], s70 offen offset:0 lds
    s_mov_b32 s68, 1
    s_mul_i32 s69, s68, 196608
    s_lshl_b32 s68, s68, 7
    s_add_u32 m0, s73, 106496
    s_add_u32 s68, s68, s60
    buffer_load_dwordx4 v2, s[28:31], s68 offen lds
    s_add_u32 m0, s61, 89088
    s_add_u32 s70, s69, s93
    buffer_load_dwordx4 v3, s[32:35], s70 offen offset:1024 lds
    s_add_u32 m0, s73, 107520
    s_nop 0
    buffer_load_dwordx4 v17, s[28:31], s68 offen lds
    s_add_u32 m0, s61, 96256
    s_add_u32 s70, s69, s94
    buffer_load_dwordx4 v3, s[32:35], s70 offen offset:2048 lds
    s_add_u32 m0, s61, 81920
    s_add_u32 s70, s69, s62
    buffer_load_dwordx4 v3, s[32:35], s70 offen offset:0 lds
    s_mov_b32 s44, s20
    s_mov_b32 s45, s21
    s_mov_b32 s46, 33554432
    s_mov_b32 s47, 0x00020000
    s_barrier
    s_mul_i32 s68, s25, 43
    s_lshr_b32 s68, s68, 8
    s_mul_i32 s68, s68, 6
    s_sub_u32 s25, s25, s68
    s_add_u32 s68, s25, 2
    s_and_b32 s68, s68, 7
    s_mul_i32 s69, s68, 196608
    s_lshl_b32 s68, s68, 7
    s_add_u32 m0, s73, 24576
    s_add_u32 s68, s68, s60
    buffer_load_dwordx4 v2, s[28:31], s68 offen lds
    s_add_u32 m0, s61, 7168
    s_add_u32 s70, s69, s93
    buffer_load_dwordx4 v3, s[32:35], s70 offen offset:1024 lds
    s_add_u32 m0, s73, 25600
    s_nop 0
    buffer_load_dwordx4 v17, s[28:31], s68 offen lds
    s_add_u32 m0, s61, 14336
    s_add_u32 s70, s69, s94
    buffer_load_dwordx4 v3, s[32:35], s70 offen offset:2048 lds
    s_add_u32 m0, s61, 0
    s_add_u32 s70, s69, s62
    buffer_load_dwordx4 v3, s[32:35], s70 offen offset:0 lds
    s_waitcnt vmcnt(10)
    s_barrier
    s_mov_b32 s48, s18
    s_mov_b32 s49, s19
    s_mov_b32 s50, 256
    s_mov_b32 s51, 0x00020000
    v_mov_b32 v16, 0
    s_lshr_b32 s71, s22, 1
    s_and_b32 s72, s22, 1
    s_lshl_b32 s91, s23, 2
    s_add_u32 s91, s91, s71
    s_lshl_b32 s74, s91, 17
    s_lshl_b32 s90, s72, 11
    s_add_u32 s74, s74, s90
    s_lshl_b32 s83, s91, 6
    s_lshl_b32 s90, s24, 1
    s_add_u32 s83, s83, s90
    s_add_u32 s83, s83, s72
    s_lshl_b32 s83, s83, 10
    s_add_u32 s83, s83, 10485760
    s_xor_b32 s84, s83, 1024
    s_mov_b32 s78, 0x0000ffff
    s_mov_b32 s79, 0x0000ffff
    s_and_b32 s95, s24, 24
    v_lshlrev_b32 v8, 4, v0
    v_and_b32 v4, 15, v0
    s_waitcnt vmcnt(5)
    s_barrier
    s_add_u32 s25, s25, 1
    s_cmp_eq_u32 s25, 6
    s_cselect_b32 s25, 0, s25
    s_add_u32 s68, s25, 2
    s_and_b32 s68, s68, 7
    s_mul_i32 s69, s68, 196608
    s_lshl_b32 s68, s68, 7
    s_add_u32 m0, s73, 65536
    s_add_u32 s68, s68, s60
    buffer_load_dwordx4 v2, s[28:31], s68 offen lds
    s_add_u32 m0, s61, 48128
    s_add_u32 s70, s69, s93
    buffer_load_dwordx4 v3, s[32:35], s70 offen offset:1024 lds
    s_add_u32 m0, s73, 66560
    s_nop 0
    buffer_load_dwordx4 v17, s[28:31], s68 offen lds
    s_add_u32 m0, s61, 55296
    s_add_u32 s70, s69, s94
    buffer_load_dwordx4 v3, s[32:35], s70 offen offset:2048 lds
    s_add_u32 m0, s61, 40960
    s_add_u32 s70, s69, s62
    buffer_load_dwordx4 v3, s[32:35], s70 offen offset:0 lds
    v_lshlrev_b32 v5, 4, v4
    v_lshrrev_b32 v6, 5, v0
    v_lshl_add_u32 v9, v6, 8, v5
    v_mov_b32 v10, 0xdddddddd
    v_and_b32 v19, 0x33, v0
    v_bfe_u32 v6, v0, 2, 1
    v_lshl_add_u32 v19, v6, 3, v19
    v_bfe_u32 v6, v0, 3, 1
    v_lshl_add_u32 v19, v6, 2, v19
    v_lshlrev_b32 v19, 4, v19
    s_and_b32 s92, s23, 4
    s_sub_u32 s90, s23, 1
    s_and_b32 s90, s90, 3
    s_or_b32 s90, s90, s92
    s_lshl_b32 s90, s90, 11
    s_sub_u32 s91, s23, 2
    s_and_b32 s91, s91, 3
    s_or_b32 s91, s91, s92
    s_lshl_b32 s91, s91, 11
    v_mov_b32 v5, s90
    v_mov_b32 v6, s91
    v_cmp_gt_u32 vcc, 16, v0
    s_lshl_b32 s90, s23, 4
    s_lshr_b32 s91, s24, 1
    v_cndmask_b32 v5, v6, v5, vcc
    s_waitcnt vmcnt(5)
    s_barrier
    s_add_u32 s25, s25, 1
    s_cmp_eq_u32 s25, 6
    s_cselect_b32 s25, 0, s25
    s_add_u32 s68, s25, 2
    s_and_b32 s68, s68, 7
    s_mul_i32 s69, s68, 196608
    s_lshl_b32 s68, s68, 7
    s_add_u32 m0, s73, 106496
    s_add_u32 s68, s68, s60
    buffer_load_dwordx4 v2, s[28:31], s68 offen lds
    s_add_u32 m0, s61, 89088
    s_add_u32 s70, s69, s93
    buffer_load_dwordx4 v3, s[32:35], s70 offen offset:1024 lds
    s_add_u32 m0, s73, 107520
    s_nop 0
    buffer_load_dwordx4 v17, s[28:31], s68 offen lds
    s_add_u32 m0, s61, 96256
    s_add_u32 s70, s69, s94
    buffer_load_dwordx4 v3, s[32:35], s70 offen offset:2048 lds
    s_add_u32 m0, s61, 81920
    s_add_u32 s70, s69, s62
    buffer_load_dwordx4 v3, s[32:35], s70 offen offset:0 lds
    v_lshl_add_u32 v11, v4, 7, v5
    s_add_u32 s90, s90, s91
    s_lshl_b32 s90, s90, 7
    s_mov_b32 s82, 8388608
    v_writelane_b32 v11, s90, 32
    v_mov_b32 v7, 155648
    v_and_b32 v4, 27, v0
    v_cmp_eq_u32 vcc, 16, v4
    v_mov_b32 v5, 0x3f803f80
    s_nop 0
    v_cndmask_b32 v5, 0, v5, vcc
    v_mov_b32 v116, v5
    v_mov_b32 v117, v5
    v_mov_b32 v118, v5
    v_mov_b32 v119, v5
    v_mov_b32 v120, v5
    v_mov_b32 v121, v5
    v_mov_b32 v122, v5
    v_mov_b32 v123, v5
    v_mov_b32 v124, v5
    v_mov_b32 v125, v5
    v_mov_b32 v126, v5
    v_mov_b32 v127, v5
    v_mov_b32 v128, v5
    s_waitcnt vmcnt(5)
    s_barrier
    s_add_u32 s25, s25, 1
    s_cmp_eq_u32 s25, 6
    s_cselect_b32 s25, 0, s25
    s_add_u32 s68, s25, 2
    s_and_b32 s68, s68, 7
    s_mul_i32 s69, s68, 196608
    s_lshl_b32 s68, s68, 7
    s_add_u32 m0, s73, 24576
    s_add_u32 s68, s68, s60
    buffer_load_dwordx4 v2, s[28:31], s68 offen lds
    s_add_u32 m0, s61, 7168
    s_add_u32 s70, s69, s93
    buffer_load_dwordx4 v3, s[32:35], s70 offen offset:1024 lds
    s_add_u32 m0, s73, 25600
    s_nop 0
    buffer_load_dwordx4 v17, s[28:31], s68 offen lds
    s_add_u32 m0, s61, 14336
    s_add_u32 s70, s69, s94
    buffer_load_dwordx4 v3, s[32:35], s70 offen offset:2048 lds
    s_add_u32 m0, s61, 0
    s_add_u32 s70, s69, s62
    buffer_load_dwordx4 v3, s[32:35], s70 offen offset:0 lds
    v_mov_b32 v129, v5
    v_mov_b32 v130, v5
    v_mov_b32 v131, v5
    v_mov_b32 v132, v5
    v_mov_b32 v133, v5
    v_mov_b32 v134, v5
    v_mov_b32 v135, v5
    v_mov_b32 v136, v5
    v_mov_b32 v137, v5
    v_mov_b32 v138, v5
    v_mov_b32 v139, v5
    v_mov_b32 v140, v5
    v_mov_b32 v141, v5
    v_mov_b32 v142, v5
    v_mov_b32 v143, v5
    v_mov_b32 v144, v5
    v_mov_b32 v145, v5
    v_mov_b32 v146, v5
    v_mov_b32 v147, v5
    v_mov_b32 v148, v5
    v_mov_b32 v149, v5
    v_mov_b32 v150, v5
    v_mov_b32 v151, v5
    v_mov_b32 v152, v5
    s_waitcnt vmcnt(5)
    s_barrier
    s_add_u32 s25, s25, 1
    s_cmp_eq_u32 s25, 6
    s_cselect_b32 s25, 0, s25
    s_add_u32 s68, s25, 2
    s_and_b32 s68, s68, 7
    s_mul_i32 s69, s68, 196608
    s_lshl_b32 s68, s68, 7
    s_add_u32 m0, s73, 65536
    s_add_u32 s68, s68, s60
    buffer_load_dwordx4 v2, s[28:31], s68 offen lds
    s_add_u32 m0, s61, 48128
    s_add_u32 s70, s69, s93
    buffer_load_dwordx4 v3, s[32:35], s70 offen offset:1024 lds
    s_add_u32 m0, s73, 66560
    s_nop 0
    buffer_load_dwordx4 v17, s[28:31], s68 offen lds
    s_add_u32 m0, s61, 55296
    s_add_u32 s70, s69, s94
    buffer_load_dwordx4 v3, s[32:35], s70 offen offset:2048 lds
    s_add_u32 m0, s61, 40960
    s_add_u32 s70, s69, s62
    buffer_load_dwordx4 v3, s[32:35], s70 offen offset:0 lds
    v_mov_b32 v153, v5
    v_mov_b32 v154, v5
    v_mov_b32 v155, v5
    v_mov_b32 v156, v5
    v_mov_b32 v157, v5
    v_mov_b32 v158, v5
    v_mov_b32 v159, v5
    v_mov_b32 v160, v5
    v_mov_b32 v161, v5
    v_mov_b32 v162, v5
    v_mov_b32 v163, v5
    v_mov_b32 v60, 0
    v_mov_b32 v61, 0
    v_mov_b32 v62, 0
    v_mov_b32 v63, 0
    v_mov_b32 v64, 0
    v_mov_b32 v65, 0
    v_mov_b32 v66, 0
    v_mov_b32 v67, 0
    v_mov_b32 v68, 0
    v_mov_b32 v69, 0
    v_mov_b32 v70, 0
    v_mov_b32 v71, 0
    v_mov_b32 v72, 0
    s_waitcnt vmcnt(5)
    s_barrier
    s_add_u32 s25, s25, 1
    s_cmp_eq_u32 s25, 6
    s_cselect_b32 s25, 0, s25
    s_add_u32 s68, s25, 2
    s_and_b32 s68, s68, 7
    s_mul_i32 s69, s68, 196608
    s_lshl_b32 s68, s68, 7
    s_add_u32 m0, s73, 106496
    s_add_u32 s68, s68, s60
    buffer_load_dwordx4 v2, s[28:31], s68 offen lds
    s_add_u32 m0, s61, 89088
    s_add_u32 s70, s69, s93
    buffer_load_dwordx4 v3, s[32:35], s70 offen offset:1024 lds
    s_add_u32 m0, s73, 107520
    s_nop 0
    buffer_load_dwordx4 v17, s[28:31], s68 offen lds
    s_add_u32 m0, s61, 96256
    s_add_u32 s70, s69, s94
    buffer_load_dwordx4 v3, s[32:35], s70 offen offset:2048 lds
    s_add_u32 m0, s61, 81920
    s_add_u32 s70, s69, s62
    buffer_load_dwordx4 v3, s[32:35], s70 offen offset:0 lds
    v_mov_b32 v73, 0
    v_mov_b32 v74, 0
    v_mov_b32 v75, 0
    v_mov_b32 v76, 0
    v_mov_b32 v77, 0
    v_mov_b32 v78, 0
    v_mov_b32 v79, 0
    v_mov_b32 v80, 0
    v_mov_b32 v81, 0
    v_mov_b32 v82, 0
    v_mov_b32 v83, 0
    v_mov_b32 v84, 0
    v_mov_b32 v85, 0
    v_mov_b32 v86, 0
    v_mov_b32 v87, 0
    v_mov_b32 v88, 0
    v_mov_b32 v89, 0
    v_mov_b32 v90, 0
    v_mov_b32 v91, 0
    s_lshl_b32 s90, s24, 1
    s_add_u32 s90, s90, s72
    s_lshl_b32 s66, s90, 5
    s_lshl_b32 s91, s23, 1
    s_add_u32 s66, s66, s91
    buffer_load_dwordx2 v[14:15], v16, s[48:51], 0 offen sc1
    s_waitcnt vmcnt(6)
    s_barrier
    s_lshr_b32 s91, s71, 1
    s_add_u32 s66, s66, s91
    s_lshl_b32 s66, s66, 10
    s_add_u32 s66, s66, 4194304
    s_lshl_b32 s63, s24, 10
    s_add_u32 s63, s63, 8650752
    s_lshl_b32 s67, s23, 7
    s_add_u32 s67, s67, s63
    s_and_b32 s90, s22, 3
    s_lshl_b32 s91, s24, 2
    s_add_u32 s91, s91, s90
    s_lshr_b32 s92, s22, 2
    s_lshl_b32 s64, s91, 1
    s_add_u32 s64, s64, s92
    s_lshl_b32 s64, s64, 13
    s_add_u32 s64, s64, 4194304
    s_lshl_b32 s65, s91, 15
    s_lshl_b32 s90, s23, 7
    s_add_u32 s65, s65, s90
    s_lshl_b32 s90, s92, 6
    s_add_u32 s65, s65, s90
    s_add_u32 s65, s65, 1024
    s_mov_b32 s85, 0x17800000
    s_mov_b32 s86, 0x6f800000
    s_waitcnt vmcnt(1)
    s_barrier
    s_waitcnt vmcnt(0)
    s_mov_b32 s56, s16
    s_mov_b32 s57, s17
    s_mov_b32 s58, 4194304
    s_mov_b32 s59, 0x00020000
    s_mov_b32 s80, 0
L_non_1:
    v_readfirstlane_b32 s76, v14
    v_readfirstlane_b32 s77, v15
    s_add_u32 s80, s80, 1
    s_cmp_gt_u32 s80, 30000
    s_cbranch_scc1 L_nond_2
    s_cmp_eq_u32 s76, 0
    s_cselect_b32 s68, 0, s77
    s_cmp_lg_u32 s68, 0
    s_cbranch_scc1 L_nond_2
    buffer_load_dwordx2 v[14:15], v16, s[48:51], 0 offen sc1
    s_waitcnt vmcnt(0)
    s_branch L_non_1
L_nond_2:
    s_cmp_eq_u32 s26, 0
    s_cbranch_scc1 L_nomask
    s_cmp_gt_u32 s22, 5
    s_cbranch_scc1 L_nomask
    v_and_b32 v4, 31, v0
    v_lshrrev_b32 v5, 5, v0
    v_lshlrev_b32 v5, 3, v5
    v_sub_u32 v4, v4, v5
    s_lshr_b32 s68, s22, 1
    s_lshl_b32 s68, s68, 4
    s_and_b32 s69, s22, 1
    s_lshl_b32 s69, s69, 2
    s_add_u32 s68, s68, s69
    s_cmp_gt_u32 s22, 3
    s_cselect_b32 s69, 48, 0
    s_sub_u32 s68, s68, s69
    v_subrev_u32 v4, s68, v4
    v_mov_b32 v6, 0xf149f2ca
    s_mov_b32 s69, 0xfffffff1
    v_subrev_u32 v28, 0, v4
    v_and_b32 v28, s69, v28
    v_subrev_u32 v29, 1, v4
    v_and_b32 v29, s69, v29
    v_subrev_u32 v30, 2, v4
    v_and_b32 v30, s69, v30
    v_subrev_u32 v31, 3, v4
    v_and_b32 v31, s69, v31
    v_cmp_eq_u32 vcc, 0, v28
    s_nop 1
    v_cndmask_b32 v28, v6, 0, vcc
    v_cmp_eq_u32 vcc, 0, v29
    s_nop 1
    v_cndmask_b32 v29, v6, 0, vcc
    v_cmp_eq_u32 vcc, 0, v30
    s_nop 1
    v_cndmask_b32 v30, v6, 0, vcc
    v_cmp_eq_u32 vcc, 0, v31
    s_nop 1
    v_cndmask_b32 v31, v6, 0, vcc
    s_add_u32 s68, s61, 122880
    v_add_u32 v4, s68, v8
    ds_write_b128 v4, v[28:31]
    s_waitcnt lgkmcnt(0)
L_nomask:
    s_barrier
    s_barrier
    s_cmp_eq_u32 s26, 0
    s_cbranch_scc1 L_noloc
    s_and_b32 s68, s22, 3
    s_lshr_b32 s69, s22, 2
    s_lshl_b32 s70, s69, 2
    s_add_u32 s70, s70, s68
    s_lshl_b32 s90, s70, 10
    s_add_u32 s90, s90, 73728
    v_add_u32 v2, s90, v8
    s_lshl_b32 s90, s70, 11
    s_add_u32 s90, s90, 90112
    v_add_u32 v3, s90, v8
    v_add_u32 v18, s90, v9
    v_add_u32 v17, 122880, v8
    s_mov_b32 s92, 0x3eb8aa3b
    ds_read_b128 v[92:95], v17 offset:0
    ds_read_b128 v[96:99], v17 offset:1024
    ds_read_b128 v[100:103], v17 offset:2048
    ds_read_b128 v[104:107], v17 offset:3072
    ds_read_b128 v[108:111], v17 offset:4096
    ds_read_b128 v[112:115], v17 offset:5120
    ds_read_b128 v[20:23], v2
    ds_read_b128 v[24:27], v3 offset:8192
    ds_read_b128 v[76:79], v3
    s_mov_b64 exec, s[78:79]
    ds_read_b128 v[116:119], v18 offset:9216
    ds_read_b128 v[120:123], v18 offset:9728
    ds_read_b128 v[124:127], v18 offset:1536
    s_mov_b64 exec, -1
    v_bfe_u32 v6, v0, 4, 1
    v_lshl_add_u32 v6, v6, 14, v9
    s_and_b32 s90, s22, 1
    s_lshl_b32 s90, s90, 9
    v_add_u32 v6, s90, v6
    s_lshl_b32 s90, s27, 2
    s_add_u32 s90, s90, s69
    s_add_u32 s90, s90, 2
    s_lshl_b32 s90, s90, 5
    s_lshl_b32 s91, s3, 1
    s_add_u32 s90, s90, s91
    s_lshr_b32 s91, s68, 1
    s_add_u32 s90, s90, s91
    s_lshl_b32 s90, s90, 10
    s_add_u32 s90, s90, 6291456
    s_waitcnt lgkmcnt(4)
    v_mfma_f32_32x32x16_bf16 v[28:43], v[24:27], v[20:23], v[92:107]
    s_waitcnt lgkmcnt(3)
    v_mfma_f32_32x32x16_bf16 v[44:59], v[76:79], v[20:23], v[100:115]
    v_mov_b32 v60, 0
    v_mov_b32 v61, 0
    v_mov_b32 v62, 0
    v_mov_b32 v63, 0
    v_mov_b32 v64, 0
    v_mov_b32 v65, 0
    v_mov_b32 v66, 0
    v_mov_b32 v67, 0
    v_mov_b32 v68, 0
    s_nop 1
    v_max_f32 v4, v28, v29
    v_max3_f32 v5, v30, v31, v32
    v_max3_f32 v4, v4, v33, v34
    v_max3_f32 v5, v5, v35, v36
    v_max3_f32 v4, v4, v37, v38
    v_max3_f32 v5, v5, v39, v40
    v_max3_f32 v4, v4, v41, v42
    v_max3_f32 v5, v5, v43, v52
    v_max3_f32 v4, v4, v53, v54
    v_max3_f32 v5, v5, v55, v56
    v_max3_f32 v4, v4, v57, v58
    v_max3_f32 v4, v4, v5, v59
    v_mov_b32 v5, v4
    s_nop 1
    v_permlane32_swap_b32 v4, v5
    s_nop 1
    v_max_f32 v4, v4, v5
    v_mul_f32 v4, s92, v4
    v_fma_f32 v52, v52, s92, -v4
    v_fma_f32 v53, v53, s92, -v4
    v_fma_f32 v54, v54, s92, -v4
    v_fma_f32 v55, v55, s92, -v4
    v_fma_f32 v56, v56, s92, -v4
    v_fma_f32 v57, v57, s92, -v4
    v_fma_f32 v58, v58, s92, -v4
    v_fma_f32 v59, v59, s92, -v4
    v_fma_f32 v28, v28, s92, -v4
    v_fma_f32 v29, v29, s92, -v4
    v_fma_f32 v30, v30, s92, -v4
    v_fma_f32 v31, v31, s92, -v4
    v_fma_f32 v32, v32, s92, -v4
    v_fma_f32 v33, v33, s92, -v4
    v_fma_f32 v34, v34, s92, -v4
    v_fma_f32 v35, v35, s92, -v4
    v_fma_f32 v36, v36, s92, -v4
    v_fma_f32 v37, v37, s92, -v4
    v_fma_f32 v38, v38, s92, -v4
    v_fma_f32 v39, v39, s92, -v4
    v_fma_f32 v40, v40, s92, -v4
    v_fma_f32 v41, v41, s92, -v4
    v_fma_f32 v42, v42, s92, -v4
    v_fma_f32 v43, v43, s92, -v4
    s_waitcnt lgkmcnt(0)
    v_exp_f32 v52, v52
    v_exp_f32 v53, v53
    v_exp_f32 v54, v54
    v_exp_f32 v55, v55
    v_exp_f32 v56, v56
    v_exp_f32 v57, v57
    v_exp_f32 v58, v58
    v_exp_f32 v59, v59
    v_exp_f32 v28, v28
    v_exp_f32 v29, v29
    v_smfmac_f32_32x32x32_bf16 v[60:75], v[124:127], v[52:59], v10
    v_exp_f32 v30, v30
    v_exp_f32 v31, v31
    v_exp_f32 v32, v32
    v_exp_f32 v33, v33
    v_exp_f32 v34, v34
    v_exp_f32 v35, v35
    v_exp_f32 v36, v36
    v_exp_f32 v37, v37
    v_smfmac_f32_32x32x32_bf16 v[60:75], v[116:119], v[28:35], v10
    v_exp_f32 v38, v38
    v_exp_f32 v39, v39
    v_exp_f32 v40, v40
    v_exp_f32 v41, v41
    v_exp_f32 v42, v42
    v_exp_f32 v43, v43
    s_nop 1
    v_smfmac_f32_32x32x32_bf16 v[60:75], v[120:123], v[36:43], v10
    s_nop 11
    v_rcp_f32 v5, v68
    s_nop 0
    v_mul_f32 v60, v60, v5
    v_mul_f32 v61, v61, v5
    v_mul_f32 v62, v62, v5
    v_mul_f32 v63, v63, v5
    v_mul_f32 v64, v64, v5
    v_mul_f32 v65, v65, v5
    v_mul_f32 v66, v66, v5
    v_mul_f32 v67, v67, v5
    v_cvt_pk_bf16_f32 v80, v60, v61
    v_cvt_pk_bf16_f32 v81, v62, v63
    v_cvt_pk_bf16_f32 v82, v64, v65
    v_cvt_pk_bf16_f32 v83, v66, v67
    buffer_store_dwordx4 v[80:83], v6, s[44:47], s90 offen sc1
    v_mov_b32 v60, 0
    v_mov_b32 v61, 0
    v_mov_b32 v62, 0
    v_mov_b32 v63, 0
    v_mov_b32 v64, 0
    v_mov_b32 v65, 0
    v_mov_b32 v66, 0
    v_mov_b32 v67, 0
    v_mov_b32 v68, 0
    v_mov_b32 v69, 0
    v_mov_b32 v70, 0
    v_mov_b32 v71, 0
    v_mov_b32 v72, 0
    v_mov_b32 v73, 0
    v_mov_b32 v74, 0
    v_mov_b32 v75, 0
    v_mov_b32 v76, 0
    v_mov_b32 v77, 0
    v_mov_b32 v78, 0
    v_mov_b32 v79, 0
    v_mov_b32 v80, 0
    v_mov_b32 v81, 0
    v_mov_b32 v82, 0
    v_mov_b32 v83, 0
L_noloc:
    v_mov_b32 v18, 1
    s_mov_b32 s88, -1
    s_mov_b32 s89, 1
    s_cmp_lg_u32 s22, 0
    s_cbranch_scc1 L_nf2
    s_mov_b64 exec, s[88:89]
    s_mov_b32 s80, 0
    buffer_load_dwordx2 v[44:45], v11, s[44:47], s82 offen sc1
    buffer_load_dwordx2 v[46:47], v11, s[44:47], s82 offen sc1
    buffer_load_dwordx2 v[48:49], v11, s[44:47], s82 offen sc1
L_pp_3:
    s_waitcnt vmcnt(2)
    v_cmp_eq_u64 vcc, s[76:77], v[44:45]
    s_cmp_eq_u64 vcc, exec
    s_cbranch_scc1 L_ppd_4
    buffer_load_dwordx2 v[44:45], v11, s[44:47], s82 offen sc1
    s_waitcnt vmcnt(2)
    v_cmp_eq_u64 vcc, s[76:77], v[46:47]
    s_cmp_eq_u64 vcc, exec
    s_cbranch_scc1 L_ppd_4
    buffer_load_dwordx2 v[46:47], v11, s[44:47], s82 offen sc1
    s_waitcnt vmcnt(2)
    v_cmp_eq_u64 vcc, s[76:77], v[48:49]
    s_cmp_eq_u64 vcc, exec
    s_cbranch_scc1 L_ppd_4
    buffer_load_dwordx2 v[48:49], v11, s[44:47], s82 offen sc1
    s_add_u32 s80, s80, 1
    s_cmp_le_u32 s80, 30000
    s_cbranch_scc1 L_pp_3
L_ppd_4:
    s_mov_b64 exec, -1
    ds_write_b32 v7, v10 offset:32
    s_branch L_nf3
L_nf2:
    s_mov_b32 s80, 0
L_ws_5:
    ds_read_b32 v4, v7 offset:32
    s_add_u32 s80, s80, 1
    s_waitcnt lgkmcnt(0)
    v_readfirstlane_b32 s68, v4
    s_cmp_gt_u32 s80, 240000
    s_cbranch_scc1 L_wsd_6
    s_cmp_eq_u32 s68, 0
    s_cbranch_scc1 L_ws_5
L_wsd_6:
L_nf3:
    buffer_load_dwordx4 v[20:23], v8, s[44:47], s83 offen sc1
    s_add_u32 s81, s95, 0
    s_and_b32 s81, s81, 31
    s_lshl_b32 s81, s81, 12
    s_add_u32 s75, s81, s74
    buffer_load_dwordx4 v[92:95], v19, s[44:47], s75 offen sc1
    s_mov_b64 exec, s[78:79]
    buffer_load_dwordx4 v[116:119], v9, s[44:47], s75 offen offset:1024 sc1
    buffer_load_dwordx4 v[120:123], v9, s[44:47], s75 offen offset:1536 sc1
    s_mov_b64 exec, -1
    buffer_load_dwordx4 v[24:27], v8, s[44:47], s84 offen sc1
    s_add_u32 s81, s95, 1
    s_and_b32 s81, s81, 31
    s_lshl_b32 s81, s81, 12
    s_add_u32 s75, s81, s74
    buffer_load_dwordx4 v[96:99], v19, s[44:47], s75 offen sc1
    s_mov_b64 exec, s[78:79]
    buffer_load_dwordx4 v[124:127], v9, s[44:47], s75 offen offset:1024 sc1
    buffer_load_dwordx4 v[128:131], v9, s[44:47], s75 offen offset:1536 sc1
    s_mov_b64 exec, -1
    s_setprio 2
    s_waitcnt vmcnt(3)
    v_mfma_f32_32x32x16_bf16 v[28:43], v[92:95], v[20:23], 0
    s_nop 11
    v_exp_f32 v28, v28
    v_exp_f32 v29, v29
    v_exp_f32 v30, v30
    v_exp_f32 v31, v31
    v_exp_f32 v32, v32
    s_add_u32 s81, s95, 2
    s_and_b32 s81, s81, 31
    s_lshl_b32 s81, s81, 12
    s_add_u32 s75, s81, s74
    buffer_load_dwordx4 v[100:103], v19, s[44:47], s75 offen sc1
    s_mov_b64 exec, s[78:79]
    buffer_load_dwordx4 v[132:135], v9, s[44:47], s75 offen offset:1024 sc1
    buffer_load_dwordx4 v[136:139], v9, s[44:47], s75 offen offset:1536 sc1
    s_mov_b64 exec, -1
    v_mfma_f32_32x32x16_bf16 v[44:59], v[92:95], v[24:27], 0
    v_exp_f32 v33, v33
    v_exp_f32 v34, v34
    v_exp_f32 v35, v35
    v_exp_f32 v36, v36
    v_exp_f32 v37, v37
    v_smfmac_f32_32x32x32_bf16 v[60:75], v[116:119], v[28:35], v10
    v_exp_f32 v38, v38
    v_exp_f32 v39, v39
    v_exp_f32 v40, v40
    v_exp_f32 v41, v41
    v_exp_f32 v42, v42
    v_exp_f32 v43, v43
    v_exp_f32 v44, v44
    v_exp_f32 v45, v45
    v_smfmac_f32_32x32x32_bf16 v[60:75], v[120:123], v[36:43], v10
    v_exp_f32 v46, v46
    v_exp_f32 v47, v47
    v_exp_f32 v48, v48
    s_add_u32 s81, s95, 3
    s_and_b32 s81, s81, 31
    s_lshl_b32 s81, s81, 12
    s_add_u32 s75, s81, s74
    buffer_load_dwordx4 v[104:107], v19, s[44:47], s75 offen sc1
    s_mov_b64 exec, s[78:79]
    buffer_load_dwordx4 v[140:143], v9, s[44:47], s75 offen offset:1024 sc1
    buffer_load_dwordx4 v[144:147], v9, s[44:47], s75 offen offset:1536 sc1
    s_mov_b64 exec, -1
    s_waitcnt vmcnt(6)
    v_mfma_f32_32x32x16_bf16 v[28:43], v[96:99], v[20:23], 0
    v_exp_f32 v49, v49
    v_exp_f32 v50, v50
    v_exp_f32 v51, v51
    v_exp_f32 v52, v52
    v_exp_f32 v53, v53
    v_smfmac_f32_32x32x32_bf16 v[76:91], v[116:119], v[44:51], v10
    v_exp_f32 v54, v54
    v_exp_f32 v55, v55
    v_exp_f32 v56, v56
    v_exp_f32 v57, v57
    v_exp_f32 v58, v58
    v_exp_f32 v59, v59
    v_exp_f32 v28, v28
    v_exp_f32 v29, v29
    v_smfmac_f32_32x32x32_bf16 v[76:91], v[120:123], v[52:59], v10
    v_exp_f32 v30, v30
    v_exp_f32 v31, v31
    v_exp_f32 v32, v32
    s_add_u32 s81, s95, 4
    s_and_b32 s81, s81, 31
    s_lshl_b32 s81, s81, 12
    s_add_u32 s75, s81, s74
    buffer_load_dwordx4 v[108:111], v19, s[44:47], s75 offen sc1
    s_mov_b64 exec, s[78:79]
    buffer_load_dwordx4 v[148:151], v9, s[44:47], s75 offen offset:1024 sc1
    buffer_load_dwordx4 v[152:155], v9, s[44:47], s75 offen offset:1536 sc1
    s_mov_b64 exec, -1
    s_mov_b64 exec, 1
    ds_add_u32 v7, v18 offset:48
    s_mov_b64 exec, -1
    v_mfma_f32_32x32x16_bf16 v[44:59], v[96:99], v[24:27], 0
    v_exp_f32 v33, v33
    v_exp_f32 v34, v34
    v_exp_f32 v35, v35
    v_exp_f32 v36, v36
    v_exp_f32 v37, v37
    v_smfmac_f32_32x32x32_bf16 v[60:75], v[124:127], v[28:35], v10
    v_exp_f32 v38, v38
    v_exp_f32 v39, v39
    v_exp_f32 v40, v40
    v_exp_f32 v41, v41
    v_exp_f32 v42, v42
    v_exp_f32 v43, v43
    v_exp_f32 v44, v44
    v_exp_f32 v45, v45
    v_smfmac_f32_32x32x32_bf16 v[60:75], v[128:131], v[36:43], v10
    v_exp_f32 v46, v46
    v_exp_f32 v47, v47
    v_exp_f32 v48, v48
    s_add_u32 s81, s95, 5
    s_and_b32 s81, s81, 31
    s_lshl_b32 s81, s81, 12
    s_add_u32 s75, s81, s74
    buffer_load_dwordx4 v[112:115], v19, s[44:47], s75 offen sc1
    s_mov_b64 exec, s[78:79]
    buffer_load_dwordx4 v[156:159], v9, s[44:47], s75 offen offset:1024 sc1
    buffer_load_dwordx4 v[160:163], v9, s[44:47], s75 offen offset:1536 sc1
    s_mov_b64 exec, -1
    s_waitcnt vmcnt(9)
    v_mfma_f32_32x32x16_bf16 v[28:43], v[100:103], v[20:23], 0
    v_exp_f32 v49, v49
    v_exp_f32 v50, v50
    v_exp_f32 v51, v51
    v_exp_f32 v52, v52
    v_exp_f32 v53, v53
    v_smfmac_f32_32x32x32_bf16 v[76:91], v[124:127], v[44:51], v10
    v_exp_f32 v54, v54
    v_exp_f32 v55, v55
    v_exp_f32 v56, v56
    v_exp_f32 v57, v57
    v_exp_f32 v58, v58
    v_exp_f32 v59, v59
    v_exp_f32 v28, v28
    v_exp_f32 v29, v29
    v_smfmac_f32_32x32x32_bf16 v[76:91], v[128:131], v[52:59], v10
    v_exp_f32 v30, v30
    v_exp_f32 v31, v31
    v_exp_f32 v32, v32
    s_add_u32 s81, s95, 6
    s_and_b32 s81, s81, 31
    s_lshl_b32 s81, s81, 12
    s_add_u32 s75, s81, s74
    buffer_load_dwordx4 v[92:95], v19, s[44:47], s75 offen sc1
    s_mov_b64 exec, s[78:79]
    buffer_load_dwordx4 v[116:119], v9, s[44:47], s75 offen offset:1024 sc1
    buffer_load_dwordx4 v[120:123], v9, s[44:47], s75 offen offset:1536 sc1
    s_mov_b64 exec, -1
    v_mfma_f32_32x32x16_bf16 v[44:59], v[100:103], v[24:27], 0
    v_exp_f32 v33, v33
    v_exp_f32 v34, v34
    v_exp_f32 v35, v35
    v_exp_f32 v36, v36
    v_exp_f32 v37, v37
    v_smfmac_f32_32x32x32_bf16 v[60:75], v[132:135], v[28:35], v10
    v_exp_f32 v38, v38
    v_exp_f32 v39, v39
    v_exp_f32 v40, v40
    v_exp_f32 v41, v41
    v_exp_f32 v42, v42
    v_exp_f32 v43, v43
    v_exp_f32 v44, v44
    v_exp_f32 v45, v45
    v_smfmac_f32_32x32x32_bf16 v[60:75], v[136:139], v[36:43], v10
    v_exp_f32 v46, v46
    v_exp_f32 v47, v47
    v_exp_f32 v48, v48
    s_add_u32 s81, s95, 7
    s_and_b32 s81, s81, 31
    s_lshl_b32 s81, s81, 12
    s_add_u32 s75, s81, s74
    buffer_load_dwordx4 v[96:99], v19, s[44:47], s75 offen sc1
    s_mov_b64 exec, s[78:79]
    buffer_load_dwordx4 v[124:127], v9, s[44:47], s75 offen offset:1024 sc1
    buffer_load_dwordx4 v[128:131], v9, s[44:47], s75 offen offset:1536 sc1
    s_mov_b64 exec, -1
    s_waitcnt vmcnt(12)
    v_mfma_f32_32x32x16_bf16 v[28:43], v[104:107], v[20:23], 0
    v_exp_f32 v49, v49
    v_exp_f32 v50, v50
    v_exp_f32 v51, v51
    v_exp_f32 v52, v52
    v_exp_f32 v53, v53
    v_smfmac_f32_32x32x32_bf16 v[76:91], v[132:135], v[44:51], v10
    v_exp_f32 v54, v54
    v_exp_f32 v55, v55
    v_exp_f32 v56, v56
    v_exp_f32 v57, v57
    v_exp_f32 v58, v58
    v_exp_f32 v59, v59
    v_exp_f32 v28, v28
    v_exp_f32 v29, v29
    v_smfmac_f32_32x32x32_bf16 v[76:91], v[136:139], v[52:59], v10
    v_exp_f32 v30, v30
    v_exp_f32 v31, v31
    v_exp_f32 v32, v32
    s_add_u32 s81, s95, 8
    s_and_b32 s81, s81, 31
    s_lshl_b32 s81, s81, 12
    s_add_u32 s75, s81, s74
    buffer_load_dwordx4 v[100:103], v19, s[44:47], s75 offen sc1
    s_mov_b64 exec, s[78:79]
    buffer_load_dwordx4 v[132:135], v9, s[44:47], s75 offen offset:1024 sc1
    buffer_load_dwordx4 v[136:139], v9, s[44:47], s75 offen offset:1536 sc1
    s_mov_b64 exec, -1
    v_mfma_f32_32x32x16_bf16 v[44:59], v[104:107], v[24:27], 0
    v_exp_f32 v33, v33
    v_exp_f32 v34, v34
    v_exp_f32 v35, v35
    v_exp_f32 v36, v36
    v_exp_f32 v37, v37
    v_smfmac_f32_32x32x32_bf16 v[60:75], v[140:143], v[28:35], v10
    v_exp_f32 v38, v38
    v_exp_f32 v39, v39
    v_exp_f32 v40, v40
    v_exp_f32 v41, v41
    v_exp_f32 v42, v42
    v_exp_f32 v43, v43
    v_exp_f32 v44, v44
    v_exp_f32 v45, v45
    v_smfmac_f32_32x32x32_bf16 v[60:75], v[144:147], v[36:43], v10
    v_exp_f32 v46, v46
    v_exp_f32 v47, v47
    v_exp_f32 v48, v48
    s_waitcnt vmcnt(12)
    v_mfma_f32_32x32x16_bf16 v[28:43], v[108:111], v[20:23], 0
    v_exp_f32 v49, v49
    v_exp_f32 v50, v50
    v_exp_f32 v51, v51
    v_exp_f32 v52, v52
    v_exp_f32 v53, v53
    v_smfmac_f32_32x32x32_bf16 v[76:91], v[140:143], v[44:51], v10
    v_exp_f32 v54, v54
    v_exp_f32 v55, v55
    v_exp_f32 v56, v56
    v_exp_f32 v57, v57
    v_exp_f32 v58, v58
    v_exp_f32 v59, v59
    v_exp_f32 v28, v28
    v_exp_f32 v29, v29
    v_smfmac_f32_32x32x32_bf16 v[76:91], v[144:147], v[52:59], v10
    v_exp_f32 v30, v30
    v_exp_f32 v31, v31
    v_exp_f32 v32, v32
    s_add_u32 s81, s95, 9
    s_and_b32 s81, s81, 31
    s_lshl_b32 s81, s81, 12
    s_add_u32 s75, s81, s74
    buffer_load_dwordx4 v[104:107], v19, s[44:47], s75 offen sc1
    s_mov_b64 exec, s[78:79]
    buffer_load_dwordx4 v[140:143], v9, s[44:47], s75 offen offset:1024 sc1
    buffer_load_dwordx4 v[144:147], v9, s[44:47], s75 offen offset:1536 sc1
    s_mov_b64 exec, -1
    ds_write_b32 v7, v10 offset:44
    v_mfma_f32_32x32x16_bf16 v[44:59], v[108:111], v[24:27], 0
    v_exp_f32 v33, v33
    v_exp_f32 v34, v34
    v_exp_f32 v35, v35
    v_exp_f32 v36, v36
    v_exp_f32 v37, v37
    v_smfmac_f32_32x32x32_bf16 v[60:75], v[148:151], v[28:35], v10
    v_exp_f32 v38, v38
    v_exp_f32 v39, v39
    v_exp_f32 v40, v40
    v_exp_f32 v41, v41
    v_exp_f32 v42, v42
    v_exp_f32 v43, v43
    v_exp_f32 v44, v44
    v_exp_f32 v45, v45
    v_smfmac_f32_32x32x32_bf16 v[60:75], v[152:155], v[36:43], v10
    v_exp_f32 v46, v46
    v_exp_f32 v47, v47
    v_exp_f32 v48, v48
    s_waitcnt vmcnt(12)
    v_mfma_f32_32x32x16_bf16 v[28:43], v[112:115], v[20:23], 0
    v_exp_f32 v49, v49
    v_exp_f32 v50, v50
    v_exp_f32 v51, v51
    v_exp_f32 v52, v52
    v_exp_f32 v53, v53
    v_smfmac_f32_32x32x32_bf16 v[76:91], v[148:151], v[44:51], v10
    v_exp_f32 v54, v54
    v_exp_f32 v55, v55
    v_exp_f32 v56, v56
    v_exp_f32 v57, v57
    v_exp_f32 v58, v58
    v_exp_f32 v59, v59
    v_exp_f32 v28, v28
    v_exp_f32 v29, v29
    v_smfmac_f32_32x32x32_bf16 v[76:91], v[152:155], v[52:59], v10
    v_exp_f32 v30, v30
    v_exp_f32 v31, v31
    v_exp_f32 v32, v32
    s_add_u32 s81, s95, 10
    s_and_b32 s81, s81, 31
    s_lshl_b32 s81, s81, 12
    s_add_u32 s75, s81, s74
    buffer_load_dwordx4 v[108:111], v19, s[44:47], s75 offen sc1
    s_mov_b64 exec, s[78:79]
    buffer_load_dwordx4 v[148:151], v9, s[44:47], s75 offen offset:1024 sc1
    buffer_load_dwordx4 v[152:155], v9, s[44:47], s75 offen offset:1536 sc1
    s_mov_b64 exec, -1
    v_mfma_f32_32x32x16_bf16 v[44:59], v[112:115], v[24:27], 0
    v_exp_f32 v33, v33
    v_exp_f32 v34, v34
    v_exp_f32 v35, v35
    v_exp_f32 v36, v36
    v_exp_f32 v37, v37
    v_smfmac_f32_32x32x32_bf16 v[60:75], v[156:159], v[28:35], v10
    v_exp_f32 v38, v38
    v_exp_f32 v39, v39
    v_exp_f32 v40, v40
    v_exp_f32 v41, v41
    v_exp_f32 v42, v42
    v_exp_f32 v43, v43
    v_exp_f32 v44, v44
    v_exp_f32 v45, v45
    v_smfmac_f32_32x32x32_bf16 v[60:75], v[160:163], v[36:43], v10
    v_exp_f32 v46, v46
    v_exp_f32 v47, v47
    v_exp_f32 v48, v48
    s_waitcnt vmcnt(12)
    v_mfma_f32_32x32x16_bf16 v[28:43], v[92:95], v[20:23], 0
    v_exp_f32 v49, v49
    v_exp_f32 v50, v50
    v_exp_f32 v51, v51
    v_exp_f32 v52, v52
    v_exp_f32 v53, v53
    v_smfmac_f32_32x32x32_bf16 v[76:91], v[156:159], v[44:51], v10
    v_exp_f32 v54, v54
    v_exp_f32 v55, v55
    v_exp_f32 v56, v56
    v_exp_f32 v57, v57
    v_exp_f32 v58, v58
    v_exp_f32 v59, v59
    v_exp_f32 v28, v28
    v_exp_f32 v29, v29
    v_smfmac_f32_32x32x32_bf16 v[76:91], v[160:163], v[52:59], v10
    v_exp_f32 v30, v30
    v_exp_f32 v31, v31
    v_exp_f32 v32, v32
    s_add_u32 s81, s95, 11
    s_and_b32 s81, s81, 31
    s_lshl_b32 s81, s81, 12
    s_add_u32 s75, s81, s74
    buffer_load_dwordx4 v[112:115], v19, s[44:47], s75 offen sc1
    s_mov_b64 exec, s[78:79]
    buffer_load_dwordx4 v[156:159], v9, s[44:47], s75 offen offset:1024 sc1
    buffer_load_dwordx4 v[160:163], v9, s[44:47], s75 offen offset:1536 sc1
    s_mov_b64 exec, -1
    v_mfma_f32_32x32x16_bf16 v[44:59], v[92:95], v[24:27], 0
    v_exp_f32 v33, v33
    v_exp_f32 v34, v34
    v_exp_f32 v35, v35
    v_exp_f32 v36, v36
    v_exp_f32 v37, v37
    v_smfmac_f32_32x32x32_bf16 v[60:75], v[116:119], v[28:35], v10
    v_exp_f32 v38, v38
    v_exp_f32 v39, v39
    v_exp_f32 v40, v40
    v_exp_f32 v41, v41
    v_exp_f32 v42, v42
    v_exp_f32 v43, v43
    v_exp_f32 v44, v44
    v_exp_f32 v45, v45
    v_smfmac_f32_32x32x32_bf16 v[60:75], v[120:123], v[36:43], v10
    v_exp_f32 v46, v46
    v_exp_f32 v47, v47
    v_exp_f32 v48, v48
    s_waitcnt vmcnt(12)
    v_mfma_f32_32x32x16_bf16 v[28:43], v[96:99], v[20:23], 0
    v_exp_f32 v49, v49
    v_exp_f32 v50, v50
    v_exp_f32 v51, v51
    v_exp_f32 v52, v52
    v_exp_f32 v53, v53
    v_smfmac_f32_32x32x32_bf16 v[76:91], v[116:119], v[44:51], v10
    v_exp_f32 v54, v54
    v_exp_f32 v55, v55
    v_exp_f32 v56, v56
    v_exp_f32 v57, v57
    v_exp_f32 v58, v58
    v_exp_f32 v59, v59
    v_exp_f32 v28, v28
    v_exp_f32 v29, v29
    v_smfmac_f32_32x32x32_bf16 v[76:91], v[120:123], v[52:59], v10
    v_exp_f32 v30, v30
    v_exp_f32 v31, v31
    v_exp_f32 v32, v32
    s_add_u32 s81, s95, 12
    s_and_b32 s81, s81, 31
    s_lshl_b32 s81, s81, 12
    s_add_u32 s75, s81, s74
    buffer_load_dwordx4 v[92:95], v19, s[44:47], s75 offen sc1
    s_mov_b64 exec, s[78:79]
    buffer_load_dwordx4 v[116:119], v9, s[44:47], s75 offen offset:1024 sc1
    buffer_load_dwordx4 v[120:123], v9, s[44:47], s75 offen offset:1536 sc1
    s_mov_b64 exec, -1
    v_mfma_f32_32x32x16_bf16 v[44:59], v[96:99], v[24:27], 0
    v_exp_f32 v33, v33
    v_exp_f32 v34, v34
    v_exp_f32 v35, v35
    v_exp_f32 v36, v36
    v_exp_f32 v37, v37
    v_smfmac_f32_32x32x32_bf16 v[60:75], v[124:127], v[28:35], v10
    v_exp_f32 v38, v38
    v_exp_f32 v39, v39
    v_exp_f32 v40, v40
    v_exp_f32 v41, v41
    v_exp_f32 v42, v42
    v_exp_f32 v43, v43
    v_exp_f32 v44, v44
    v_exp_f32 v45, v45
    v_smfmac_f32_32x32x32_bf16 v[60:75], v[128:131], v[36:43], v10
    v_exp_f32 v46, v46
    v_exp_f32 v47, v47
    v_exp_f32 v48, v48
    s_waitcnt vmcnt(12)
    v_mfma_f32_32x32x16_bf16 v[28:43], v[100:103], v[20:23], 0
    v_exp_f32 v49, v49
    v_exp_f32 v50, v50
    v_exp_f32 v51, v51
    v_exp_f32 v52, v52
    v_exp_f32 v53, v53
    v_smfmac_f32_32x32x32_bf16 v[76:91], v[124:127], v[44:51], v10
    v_exp_f32 v54, v54
    v_exp_f32 v55, v55
    v_exp_f32 v56, v56
    v_exp_f32 v57, v57
    v_exp_f32 v58, v58
    v_exp_f32 v59, v59
    v_exp_f32 v28, v28
    v_exp_f32 v29, v29
    v_smfmac_f32_32x32x32_bf16 v[76:91], v[128:131], v[52:59], v10
    v_exp_f32 v30, v30
    v_exp_f32 v31, v31
    v_exp_f32 v32, v32
    s_add_u32 s81, s95, 13
    s_and_b32 s81, s81, 31
    s_lshl_b32 s81, s81, 12
    s_add_u32 s75, s81, s74
    buffer_load_dwordx4 v[96:99], v19, s[44:47], s75 offen sc1
    s_mov_b64 exec, s[78:79]
    buffer_load_dwordx4 v[124:127], v9, s[44:47], s75 offen offset:1024 sc1
    buffer_load_dwordx4 v[128:131], v9, s[44:47], s75 offen offset:1536 sc1
    s_mov_b64 exec, -1
    v_mfma_f32_32x32x16_bf16 v[44:59], v[100:103], v[24:27], 0
    v_exp_f32 v33, v33
    v_exp_f32 v34, v34
    v_exp_f32 v35, v35
    v_exp_f32 v36, v36
    v_exp_f32 v37, v37
    v_smfmac_f32_32x32x32_bf16 v[60:75], v[132:135], v[28:35], v10
    v_exp_f32 v38, v38
    v_exp_f32 v39, v39
    v_exp_f32 v40, v40
    v_exp_f32 v41, v41
    v_exp_f32 v42, v42
    v_exp_f32 v43, v43
    v_exp_f32 v44, v44
    v_exp_f32 v45, v45
    v_smfmac_f32_32x32x32_bf16 v[60:75], v[136:139], v[36:43], v10
    v_exp_f32 v46, v46
    v_exp_f32 v47, v47
    v_exp_f32 v48, v48
    s_waitcnt vmcnt(12)
    v_mfma_f32_32x32x16_bf16 v[28:43], v[104:107], v[20:23], 0
    v_exp_f32 v49, v49
    v_exp_f32 v50, v50
    v_exp_f32 v51, v51
    v_exp_f32 v52, v52
    v_exp_f32 v53, v53
    v_smfmac_f32_32x32x32_bf16 v[76:91], v[132:135], v[44:51], v10
    v_exp_f32 v54, v54
    v_exp_f32 v55, v55
    v_exp_f32 v56, v56
    v_exp_f32 v57, v57
    v_exp_f32 v58, v58
    v_exp_f32 v59, v59
    v_exp_f32 v28, v28
    v_exp_f32 v29, v29
    v_smfmac_f32_32x32x32_bf16 v[76:91], v[136:139], v[52:59], v10
    v_exp_f32 v30, v30
    v_exp_f32 v31, v31
    v_exp_f32 v32, v32
    s_add_u32 s81, s95, 14
    s_and_b32 s81, s81, 31
    s_lshl_b32 s81, s81, 12
    s_add_u32 s75, s81, s74
    buffer_load_dwordx4 v[100:103], v19, s[44:47], s75 offen sc1
    s_mov_b64 exec, s[78:79]
    buffer_load_dwordx4 v[132:135], v9, s[44:47], s75 offen offset:1024 sc1
    buffer_load_dwordx4 v[136:139], v9, s[44:47], s75 offen offset:1536 sc1
    s_mov_b64 exec, -1
    v_mfma_f32_32x32x16_bf16 v[44:59], v[104:107], v[24:27], 0
    v_exp_f32 v33, v33
    v_exp_f32 v34, v34
    v_exp_f32 v35, v35
    v_exp_f32 v36, v36
    v_exp_f32 v37, v37
    v_smfmac_f32_32x32x32_bf16 v[60:75], v[140:143], v[28:35], v10
    v_exp_f32 v38, v38
    v_exp_f32 v39, v39
    v_exp_f32 v40, v40
    v_exp_f32 v41, v41
    v_exp_f32 v42, v42
    v_exp_f32 v43, v43
    v_exp_f32 v44, v44
    v_exp_f32 v45, v45
    v_smfmac_f32_32x32x32_bf16 v[60:75], v[144:147], v[36:43], v10
    v_exp_f32 v46, v46
    v_exp_f32 v47, v47
    v_exp_f32 v48, v48
    s_waitcnt vmcnt(12)
    v_mfma_f32_32x32x16_bf16 v[28:43], v[108:111], v[20:23], 0
    v_exp_f32 v49, v49
    v_exp_f32 v50, v50
    v_exp_f32 v51, v51
    v_exp_f32 v52, v52
    v_exp_f32 v53, v53
    v_smfmac_f32_32x32x32_bf16 v[76:91], v[140:143], v[44:51], v10
    v_exp_f32 v54, v54
    v_exp_f32 v55, v55
    v_exp_f32 v56, v56
    v_exp_f32 v57, v57
    v_exp_f32 v58, v58
    v_exp_f32 v59, v59
    v_exp_f32 v28, v28
    v_exp_f32 v29, v29
    v_smfmac_f32_32x32x32_bf16 v[76:91], v[144:147], v[52:59], v10
    v_exp_f32 v30, v30
    v_exp_f32 v31, v31
    v_exp_f32 v32, v32
    s_add_u32 s81, s95, 15
    s_and_b32 s81, s81, 31
    s_lshl_b32 s81, s81, 12
    s_add_u32 s75, s81, s74
    buffer_load_dwordx4 v[104:107], v19, s[44:47], s75 offen sc1
    s_mov_b64 exec, s[78:79]
    buffer_load_dwordx4 v[140:143], v9, s[44:47], s75 offen offset:1024 sc1
    buffer_load_dwordx4 v[144:147], v9, s[44:47], s75 offen offset:1536 sc1
    s_mov_b64 exec, -1
    v_mfma_f32_32x32x16_bf16 v[44:59], v[108:111], v[24:27], 0
    v_exp_f32 v33, v33
    v_exp_f32 v34, v34
    v_exp_f32 v35, v35
    v_exp_f32 v36, v36
    v_exp_f32 v37, v37
    v_smfmac_f32_32x32x32_bf16 v[60:75], v[148:151], v[28:35], v10
    v_exp_f32 v38, v38
    v_exp_f32 v39, v39
    v_exp_f32 v40, v40
    v_exp_f32 v41, v41
    v_exp_f32 v42, v42
    v_exp_f32 v43, v43
    v_exp_f32 v44, v44
    v_exp_f32 v45, v45
    v_smfmac_f32_32x32x32_bf16 v[60:75], v[152:155], v[36:43], v10
    v_exp_f32 v46, v46
    v_exp_f32 v47, v47
    v_exp_f32 v48, v48
    s_waitcnt vmcnt(12)
    v_mfma_f32_32x32x16_bf16 v[28:43], v[112:115], v[20:23], 0
    v_exp_f32 v49, v49
    v_exp_f32 v50, v50
    v_exp_f32 v51, v51
    v_exp_f32 v52, v52
    v_exp_f32 v53, v53
    v_smfmac_f32_32x32x32_bf16 v[76:91], v[148:151], v[44:51], v10
    v_exp_f32 v54, v54
    v_exp_f32 v55, v55
    v_exp_f32 v56, v56
    v_exp_f32 v57, v57
    v_exp_f32 v58, v58
    v_exp_f32 v59, v59
    v_exp_f32 v28, v28
    v_exp_f32 v29, v29
    v_smfmac_f32_32x32x32_bf16 v[76:91], v[152:155], v[52:59], v10
    v_exp_f32 v30, v30
    v_exp_f32 v31, v31
    v_exp_f32 v32, v32
    s_add_u32 s81, s95, 16
    s_and_b32 s81, s81, 31
    s_lshl_b32 s81, s81, 12
    s_add_u32 s75, s81, s74
    buffer_load_dwordx4 v[108:111], v19, s[44:47], s75 offen sc1
    s_mov_b64 exec, s[78:79]
    buffer_load_dwordx4 v[148:151], v9, s[44:47], s75 offen offset:1024 sc1
    buffer_load_dwordx4 v[152:155], v9, s[44:47], s75 offen offset:1536 sc1
    s_mov_b64 exec, -1
    v_mfma_f32_32x32x16_bf16 v[44:59], v[112:115], v[24:27], 0
    v_exp_f32 v33, v33
    v_exp_f32 v34, v34
    v_exp_f32 v35, v35
    v_exp_f32 v36, v36
    v_exp_f32 v37, v37
    v_smfmac_f32_32x32x32_bf16 v[60:75], v[156:159], v[28:35], v10
    v_exp_f32 v38, v38
    v_exp_f32 v39, v39
    v_exp_f32 v40, v40
    v_exp_f32 v41, v41
    v_exp_f32 v42, v42
    v_exp_f32 v43, v43
    v_exp_f32 v44, v44
    v_exp_f32 v45, v45
    v_smfmac_f32_32x32x32_bf16 v[60:75], v[160:163], v[36:43], v10
    v_exp_f32 v46, v46
    v_exp_f32 v47, v47
    v_exp_f32 v48, v48
    s_waitcnt vmcnt(12)
    v_mfma_f32_32x32x16_bf16 v[28:43], v[92:95], v[20:23], 0
    v_exp_f32 v49, v49
    v_exp_f32 v50, v50
    v_exp_f32 v51, v51
    v_exp_f32 v52, v52
    v_exp_f32 v53, v53
    v_smfmac_f32_32x32x32_bf16 v[76:91], v[156:159], v[44:51], v10
    v_exp_f32 v54, v54
    v_exp_f32 v55, v55
    v_exp_f32 v56, v56
    v_exp_f32 v57, v57
    v_exp_f32 v58, v58
    v_exp_f32 v59, v59
    v_exp_f32 v28, v28
    v_exp_f32 v29, v29
    v_smfmac_f32_32x32x32_bf16 v[76:91], v[160:163], v[52:59], v10
    v_exp_f32 v30, v30
    v_exp_f32 v31, v31
    v_exp_f32 v32, v32
    s_add_u32 s81, s95, 17
    s_and_b32 s81, s81, 31
    s_lshl_b32 s81, s81, 12
    s_add_u32 s75, s81, s74
    buffer_load_dwordx4 v[112:115], v19, s[44:47], s75 offen sc1
    s_mov_b64 exec, s[78:79]
    buffer_load_dwordx4 v[156:159], v9, s[44:47], s75 offen offset:1024 sc1
    buffer_load_dwordx4 v[160:163], v9, s[44:47], s75 offen offset:1536 sc1
    s_mov_b64 exec, -1
    v_mfma_f32_32x32x16_bf16 v[44:59], v[92:95], v[24:27], 0
    v_exp_f32 v33, v33
    v_exp_f32 v34, v34
    v_exp_f32 v35, v35
    v_exp_f32 v36, v36
    v_exp_f32 v37, v37
    v_smfmac_f32_32x32x32_bf16 v[60:75], v[116:119], v[28:35], v10
    v_exp_f32 v38, v38
    v_exp_f32 v39, v39
    v_exp_f32 v40, v40
    v_exp_f32 v41, v41
    v_exp_f32 v42, v42
    v_exp_f32 v43, v43
    v_exp_f32 v44, v44
    v_exp_f32 v45, v45
    v_smfmac_f32_32x32x32_bf16 v[60:75], v[120:123], v[36:43], v10
    v_exp_f32 v46, v46
    v_exp_f32 v47, v47
    v_exp_f32 v48, v48
    s_waitcnt vmcnt(12)
    v_mfma_f32_32x32x16_bf16 v[28:43], v[96:99], v[20:23], 0
    v_exp_f32 v49, v49
    v_exp_f32 v50, v50
    v_exp_f32 v51, v51
    v_exp_f32 v52, v52
    v_exp_f32 v53, v53
    v_smfmac_f32_32x32x32_bf16 v[76:91], v[116:119], v[44:51], v10
    v_exp_f32 v54, v54
    v_exp_f32 v55, v55
    v_exp_f32 v56, v56
    v_exp_f32 v57, v57
    v_exp_f32 v58, v58
    v_exp_f32 v59, v59
    v_exp_f32 v28, v28
    v_exp_f32 v29, v29
    v_smfmac_f32_32x32x32_bf16 v[76:91], v[120:123], v[52:59], v10
    v_exp_f32 v30, v30
    v_exp_f32 v31, v31
    v_exp_f32 v32, v32
    s_add_u32 s81, s95, 18
    s_and_b32 s81, s81, 31
    s_lshl_b32 s81, s81, 12
    s_add_u32 s75, s81, s74
    buffer_load_dwordx4 v[92:95], v19, s[44:47], s75 offen sc1
    s_mov_b64 exec, s[78:79]
    buffer_load_dwordx4 v[116:119], v9, s[44:47], s75 offen offset:1024 sc1
    buffer_load_dwordx4 v[120:123], v9, s[44:47], s75 offen offset:1536 sc1
    s_mov_b64 exec, -1
    v_mfma_f32_32x32x16_bf16 v[44:59], v[96:99], v[24:27], 0
    v_exp_f32 v33, v33
    v_exp_f32 v34, v34
    v_exp_f32 v35, v35
    v_exp_f32 v36, v36
    v_exp_f32 v37, v37
    v_smfmac_f32_32x32x32_bf16 v[60:75], v[124:127], v[28:35], v10
    v_exp_f32 v38, v38
    v_exp_f32 v39, v39
    v_exp_f32 v40, v40
    v_exp_f32 v41, v41
    v_exp_f32 v42, v42
    v_exp_f32 v43, v43
    v_exp_f32 v44, v44
    v_exp_f32 v45, v45
    v_smfmac_f32_32x32x32_bf16 v[60:75], v[128:131], v[36:43], v10
    v_exp_f32 v46, v46
    v_exp_f32 v47, v47
    v_exp_f32 v48, v48
    s_waitcnt vmcnt(12)
    v_mfma_f32_32x32x16_bf16 v[28:43], v[100:103], v[20:23], 0
    v_exp_f32 v49, v49
    v_exp_f32 v50, v50
    v_exp_f32 v51, v51
    v_exp_f32 v52, v52
    v_exp_f32 v53, v53
    v_smfmac_f32_32x32x32_bf16 v[76:91], v[124:127], v[44:51], v10
    v_exp_f32 v54, v54
    v_exp_f32 v55, v55
    v_exp_f32 v56, v56
    v_exp_f32 v57, v57
    v_exp_f32 v58, v58
    v_exp_f32 v59, v59
    v_exp_f32 v28, v28
    v_exp_f32 v29, v29
    v_smfmac_f32_32x32x32_bf16 v[76:91], v[128:131], v[52:59], v10
    v_exp_f32 v30, v30
    v_exp_f32 v31, v31
    v_exp_f32 v32, v32
    s_add_u32 s81, s95, 19
    s_and_b32 s81, s81, 31
    s_lshl_b32 s81, s81, 12
    s_add_u32 s75, s81, s74
    buffer_load_dwordx4 v[96:99], v19, s[44:47], s75 offen sc1
    s_mov_b64 exec, s[78:79]
    buffer_load_dwordx4 v[124:127], v9, s[44:47], s75 offen offset:1024 sc1
    buffer_load_dwordx4 v[128:131], v9, s[44:47], s75 offen offset:1536 sc1
    s_mov_b64 exec, -1
    s_setprio 1
    v_mfma_f32_32x32x16_bf16 v[44:59], v[100:103], v[24:27], 0
    v_exp_f32 v33, v33
    v_exp_f32 v34, v34
    v_exp_f32 v35, v35
    v_exp_f32 v36, v36
    v_exp_f32 v37, v37
    v_smfmac_f32_32x32x32_bf16 v[60:75], v[132:135], v[28:35], v10
    v_exp_f32 v38, v38
    v_exp_f32 v39, v39
    v_exp_f32 v40, v40
    v_exp_f32 v41, v41
    v_exp_f32 v42, v42
    v_exp_f32 v43, v43
    v_exp_f32 v44, v44
    v_exp_f32 v45, v45
    v_smfmac_f32_32x32x32_bf16 v[60:75], v[136:139], v[36:43], v10
    v_exp_f32 v46, v46
    v_exp_f32 v47, v47
    v_exp_f32 v48, v48
    s_waitcnt vmcnt(12)
    v_mfma_f32_32x32x16_bf16 v[28:43], v[104:107], v[20:23], 0
    v_exp_f32 v49, v49
    v_exp_f32 v50, v50
    v_exp_f32 v51, v51
    v_exp_f32 v52, v52
    v_exp_f32 v53, v53
    v_smfmac_f32_32x32x32_bf16 v[76:91], v[132:135], v[44:51], v10
    v_exp_f32 v54, v54
    v_exp_f32 v55, v55
    v_exp_f32 v56, v56
    v_exp_f32 v57, v57
    v_exp_f32 v58, v58
    v_exp_f32 v59, v59
    v_exp_f32 v28, v28
    v_exp_f32 v29, v29
    v_smfmac_f32_32x32x32_bf16 v[76:91], v[136:139], v[52:59], v10
    v_exp_f32 v30, v30
    v_exp_f32 v31, v31
    v_exp_f32 v32, v32
    s_add_u32 s81, s95, 20
    s_and_b32 s81, s81, 31
    s_lshl_b32 s81, s81, 12
    s_add_u32 s75, s81, s74
    buffer_load_dwordx4 v[100:103], v19, s[44:47], s75 offen sc1
    s_mov_b64 exec, s[78:79]
    buffer_load_dwordx4 v[132:135], v9, s[44:47], s75 offen offset:1024 sc1
    buffer_load_dwordx4 v[136:139], v9, s[44:47], s75 offen offset:1536 sc1
    s_mov_b64 exec, -1
    v_mfma_f32_32x32x16_bf16 v[44:59], v[104:107], v[24:27], 0
    v_exp_f32 v33, v33
    v_exp_f32 v34, v34
    v_exp_f32 v35, v35
    v_exp_f32 v36, v36
    v_exp_f32 v37, v37
    v_smfmac_f32_32x32x32_bf16 v[60:75], v[140:143], v[28:35], v10
    v_exp_f32 v38, v38
    v_exp_f32 v39, v39
    v_exp_f32 v40, v40
    v_exp_f32 v41, v41
    v_exp_f32 v42, v42
    v_exp_f32 v43, v43
    v_exp_f32 v44, v44
    v_exp_f32 v45, v45
    v_smfmac_f32_32x32x32_bf16 v[60:75], v[144:147], v[36:43], v10
    v_exp_f32 v46, v46
    v_exp_f32 v47, v47
    v_exp_f32 v48, v48
    s_waitcnt vmcnt(12)
    v_mfma_f32_32x32x16_bf16 v[28:43], v[108:111], v[20:23], 0
    v_exp_f32 v49, v49
    v_exp_f32 v50, v50
    v_exp_f32 v51, v51
    v_exp_f32 v52, v52
    v_exp_f32 v53, v53
    v_smfmac_f32_32x32x32_bf16 v[76:91], v[140:143], v[44:51], v10
    v_exp_f32 v54, v54
    v_exp_f32 v55, v55
    v_exp_f32 v56, v56
    v_exp_f32 v57, v57
    v_exp_f32 v58, v58
    v_exp_f32 v59, v59
    v_exp_f32 v28, v28
    v_exp_f32 v29, v29
    v_smfmac_f32_32x32x32_bf16 v[76:91], v[144:147], v[52:59], v10
    v_exp_f32 v30, v30
    v_exp_f32 v31, v31
    v_exp_f32 v32, v32
    s_add_u32 s81, s95, 21
    s_and_b32 s81, s81, 31
    s_lshl_b32 s81, s81, 12
    s_add_u32 s75, s81, s74
    buffer_load_dwordx4 v[104:107], v19, s[44:47], s75 offen sc1
    s_mov_b64 exec, s[78:79]
    buffer_load_dwordx4 v[140:143], v9, s[44:47], s75 offen offset:1024 sc1
    buffer_load_dwordx4 v[144:147], v9, s[44:47], s75 offen offset:1536 sc1
    s_mov_b64 exec, -1
    v_mfma_f32_32x32x16_bf16 v[44:59], v[108:111], v[24:27], 0
    v_exp_f32 v33, v33
    v_exp_f32 v34, v34
    v_exp_f32 v35, v35
    v_exp_f32 v36, v36
    v_exp_f32 v37, v37
    v_smfmac_f32_32x32x32_bf16 v[60:75], v[148:151], v[28:35], v10
    v_exp_f32 v38, v38
    v_exp_f32 v39, v39
    v_exp_f32 v40, v40
    v_exp_f32 v41, v41
    v_exp_f32 v42, v42
    v_exp_f32 v43, v43
    v_exp_f32 v44, v44
    v_exp_f32 v45, v45
    v_smfmac_f32_32x32x32_bf16 v[60:75], v[152:155], v[36:43], v10
    v_exp_f32 v46, v46
    v_exp_f32 v47, v47
    v_exp_f32 v48, v48
    s_waitcnt vmcnt(12)
    v_mfma_f32_32x32x16_bf16 v[28:43], v[112:115], v[20:23], 0
    v_exp_f32 v49, v49
    v_exp_f32 v50, v50
    v_exp_f32 v51, v51
    v_exp_f32 v52, v52
    v_exp_f32 v53, v53
    v_smfmac_f32_32x32x32_bf16 v[76:91], v[148:151], v[44:51], v10
    v_exp_f32 v54, v54
    v_exp_f32 v55, v55
    v_exp_f32 v56, v56
    v_exp_f32 v57, v57
    v_exp_f32 v58, v58
    v_exp_f32 v59, v59
    v_exp_f32 v28, v28
    v_exp_f32 v29, v29
    v_smfmac_f32_32x32x32_bf16 v[76:91], v[152:155], v[52:59], v10
    v_exp_f32 v30, v30
    v_exp_f32 v31, v31
    v_exp_f32 v32, v32
    s_add_u32 s81, s95, 22
    s_and_b32 s81, s81, 31
    s_lshl_b32 s81, s81, 12
    s_add_u32 s75, s81, s74
    buffer_load_dwordx4 v[108:111], v19, s[44:47], s75 offen sc1
    s_mov_b64 exec, s[78:79]
    buffer_load_dwordx4 v[148:151], v9, s[44:47], s75 offen offset:1024 sc1
    buffer_load_dwordx4 v[152:155], v9, s[44:47], s75 offen offset:1536 sc1
    s_mov_b64 exec, -1
    v_mfma_f32_32x32x16_bf16 v[44:59], v[112:115], v[24:27], 0
    v_exp_f32 v33, v33
    v_exp_f32 v34, v34
    v_exp_f32 v35, v35
    v_exp_f32 v36, v36
    v_exp_f32 v37, v37
    v_smfmac_f32_32x32x32_bf16 v[60:75], v[156:159], v[28:35], v10
    v_exp_f32 v38, v38
    v_exp_f32 v39, v39
    v_exp_f32 v40, v40
    v_exp_f32 v41, v41
    v_exp_f32 v42, v42
    v_exp_f32 v43, v43
    v_exp_f32 v44, v44
    v_exp_f32 v45, v45
    v_smfmac_f32_32x32x32_bf16 v[60:75], v[160:163], v[36:43], v10
    v_exp_f32 v46, v46
    v_exp_f32 v47, v47
    v_exp_f32 v48, v48
    s_waitcnt vmcnt(12)
    v_mfma_f32_32x32x16_bf16 v[28:43], v[92:95], v[20:23], 0
    v_exp_f32 v49, v49
    v_exp_f32 v50, v50
    v_exp_f32 v51, v51
    v_exp_f32 v52, v52
    v_exp_f32 v53, v53
    v_smfmac_f32_32x32x32_bf16 v[76:91], v[156:159], v[44:51], v10
    v_exp_f32 v54, v54
    v_exp_f32 v55, v55
    v_exp_f32 v56, v56
    v_exp_f32 v57, v57
    v_exp_f32 v58, v58
    v_exp_f32 v59, v59
    v_exp_f32 v28, v28
    v_exp_f32 v29, v29
    v_smfmac_f32_32x32x32_bf16 v[76:91], v[160:163], v[52:59], v10
    v_exp_f32 v30, v30
    v_exp_f32 v31, v31
    v_exp_f32 v32, v32
    s_add_u32 s81, s95, 23
    s_and_b32 s81, s81, 31
    s_lshl_b32 s81, s81, 12
    s_add_u32 s75, s81, s74
    buffer_load_dwordx4 v[112:115], v19, s[44:47], s75 offen sc1
    s_mov_b64 exec, s[78:79]
    buffer_load_dwordx4 v[156:159], v9, s[44:47], s75 offen offset:1024 sc1
    buffer_load_dwordx4 v[160:163], v9, s[44:47], s75 offen offset:1536 sc1
    s_mov_b64 exec, -1
    v_mfma_f32_32x32x16_bf16 v[44:59], v[92:95], v[24:27], 0
    v_exp_f32 v33, v33
    v_exp_f32 v34, v34
    v_exp_f32 v35, v35
    v_exp_f32 v36, v36
    v_exp_f32 v37, v37
    v_smfmac_f32_32x32x32_bf16 v[60:75], v[116:119], v[28:35], v10
    v_exp_f32 v38, v38
    v_exp_f32 v39, v39
    v_exp_f32 v40, v40
    v_exp_f32 v41, v41
    v_exp_f32 v42, v42
    v_exp_f32 v43, v43
    v_exp_f32 v44, v44
    v_exp_f32 v45, v45
    v_smfmac_f32_32x32x32_bf16 v[60:75], v[120:123], v[36:43], v10
    v_exp_f32 v46, v46
    v_exp_f32 v47, v47
    v_exp_f32 v48, v48
    s_waitcnt vmcnt(12)
    v_mfma_f32_32x32x16_bf16 v[28:43], v[96:99], v[20:23], 0
    v_exp_f32 v49, v49
    v_exp_f32 v50, v50
    v_exp_f32 v51, v51
    v_exp_f32 v52, v52
    v_exp_f32 v53, v53
    v_smfmac_f32_32x32x32_bf16 v[76:91], v[116:119], v[44:51], v10
    v_exp_f32 v54, v54
    v_exp_f32 v55, v55
    v_exp_f32 v56, v56
    v_exp_f32 v57, v57
    v_exp_f32 v58, v58
    v_exp_f32 v59, v59
    v_exp_f32 v28, v28
    v_exp_f32 v29, v29
    v_smfmac_f32_32x32x32_bf16 v[76:91], v[120:123], v[52:59], v10
    v_exp_f32 v30, v30
    v_exp_f32 v31, v31
    v_exp_f32 v32, v32
    s_add_u32 s81, s95, 24
    s_and_b32 s81, s81, 31
    s_lshl_b32 s81, s81, 12
    s_add_u32 s75, s81, s74
    buffer_load_dwordx4 v[92:95], v19, s[44:47], s75 offen sc1
    s_mov_b64 exec, s[78:79]
    buffer_load_dwordx4 v[116:119], v9, s[44:47], s75 offen offset:1024 sc1
    buffer_load_dwordx4 v[120:123], v9, s[44:47], s75 offen offset:1536 sc1
    s_mov_b64 exec, -1
    v_mfma_f32_32x32x16_bf16 v[44:59], v[96:99], v[24:27], 0
    v_exp_f32 v33, v33
    v_exp_f32 v34, v34
    v_exp_f32 v35, v35
    v_exp_f32 v36, v36
    v_exp_f32 v37, v37
    v_smfmac_f32_32x32x32_bf16 v[60:75], v[124:127], v[28:35], v10
    v_exp_f32 v38, v38
    v_exp_f32 v39, v39
    v_exp_f32 v40, v40
    v_exp_f32 v41, v41
    v_exp_f32 v42, v42
    v_exp_f32 v43, v43
    v_exp_f32 v44, v44
    v_exp_f32 v45, v45
    v_smfmac_f32_32x32x32_bf16 v[60:75], v[128:131], v[36:43], v10
    v_exp_f32 v46, v46
    v_exp_f32 v47, v47
    v_exp_f32 v48, v48
    s_waitcnt vmcnt(12)
    v_mfma_f32_32x32x16_bf16 v[28:43], v[100:103], v[20:23], 0
    v_exp_f32 v49, v49
    v_exp_f32 v50, v50
    v_exp_f32 v51, v51
    v_exp_f32 v52, v52
    v_exp_f32 v53, v53
    v_smfmac_f32_32x32x32_bf16 v[76:91], v[124:127], v[44:51], v10
    v_exp_f32 v54, v54
    v_exp_f32 v55, v55
    v_exp_f32 v56, v56
    v_exp_f32 v57, v57
    v_exp_f32 v58, v58
    v_exp_f32 v59, v59
    v_exp_f32 v28, v28
    v_exp_f32 v29, v29
    v_smfmac_f32_32x32x32_bf16 v[76:91], v[128:131], v[52:59], v10
    v_exp_f32 v30, v30
    v_exp_f32 v31, v31
    v_exp_f32 v32, v32
    s_add_u32 s81, s95, 25
    s_and_b32 s81, s81, 31
    s_lshl_b32 s81, s81, 12
    s_add_u32 s75, s81, s74
    buffer_load_dwordx4 v[96:99], v19, s[44:47], s75 offen sc1
    s_mov_b64 exec, s[78:79]
    buffer_load_dwordx4 v[124:127], v9, s[44:47], s75 offen offset:1024 sc1
    buffer_load_dwordx4 v[128:131], v9, s[44:47], s75 offen offset:1536 sc1
    s_mov_b64 exec, -1
    v_mfma_f32_32x32x16_bf16 v[44:59], v[100:103], v[24:27], 0
    v_exp_f32 v33, v33
    v_exp_f32 v34, v34
    v_exp_f32 v35, v35
    v_exp_f32 v36, v36
    v_exp_f32 v37, v37
    v_smfmac_f32_32x32x32_bf16 v[60:75], v[132:135], v[28:35], v10
    v_exp_f32 v38, v38
    v_exp_f32 v39, v39
    v_exp_f32 v40, v40
    v_exp_f32 v41, v41
    v_exp_f32 v42, v42
    v_exp_f32 v43, v43
    v_exp_f32 v44, v44
    v_exp_f32 v45, v45
    v_smfmac_f32_32x32x32_bf16 v[60:75], v[136:139], v[36:43], v10
    v_exp_f32 v46, v46
    v_exp_f32 v47, v47
    v_exp_f32 v48, v48
    s_waitcnt vmcnt(12)
    v_mfma_f32_32x32x16_bf16 v[28:43], v[104:107], v[20:23], 0
    v_exp_f32 v49, v49
    v_exp_f32 v50, v50
    v_exp_f32 v51, v51
    v_exp_f32 v52, v52
    v_exp_f32 v53, v53
    v_smfmac_f32_32x32x32_bf16 v[76:91], v[132:135], v[44:51], v10
    v_exp_f32 v54, v54
    v_exp_f32 v55, v55
    v_exp_f32 v56, v56
    v_exp_f32 v57, v57
    v_exp_f32 v58, v58
    v_exp_f32 v59, v59
    v_exp_f32 v28, v28
    v_exp_f32 v29, v29
    v_smfmac_f32_32x32x32_bf16 v[76:91], v[136:139], v[52:59], v10
    v_exp_f32 v30, v30
    v_exp_f32 v31, v31
    v_exp_f32 v32, v32
    s_add_u32 s81, s95, 26
    s_and_b32 s81, s81, 31
    s_lshl_b32 s81, s81, 12
    s_add_u32 s75, s81, s74
    buffer_load_dwordx4 v[100:103], v19, s[44:47], s75 offen sc1
    s_mov_b64 exec, s[78:79]
    buffer_load_dwordx4 v[132:135], v9, s[44:47], s75 offen offset:1024 sc1
    buffer_load_dwordx4 v[136:139], v9, s[44:47], s75 offen offset:1536 sc1
    s_mov_b64 exec, -1
    v_mfma_f32_32x32x16_bf16 v[44:59], v[104:107], v[24:27], 0
    v_exp_f32 v33, v33
    v_exp_f32 v34, v34
    v_exp_f32 v35, v35
    v_exp_f32 v36, v36
    v_exp_f32 v37, v37
    v_smfmac_f32_32x32x32_bf16 v[60:75], v[140:143], v[28:35], v10
    v_exp_f32 v38, v38
    v_exp_f32 v39, v39
    v_exp_f32 v40, v40
    v_exp_f32 v41, v41
    v_exp_f32 v42, v42
    v_exp_f32 v43, v43
    v_exp_f32 v44, v44
    v_exp_f32 v45, v45
    v_smfmac_f32_32x32x32_bf16 v[60:75], v[144:147], v[36:43], v10
    v_exp_f32 v46, v46
    v_exp_f32 v47, v47
    v_exp_f32 v48, v48
    s_waitcnt vmcnt(12)
    v_mfma_f32_32x32x16_bf16 v[28:43], v[108:111], v[20:23], 0
    v_exp_f32 v49, v49
    v_exp_f32 v50, v50
    v_exp_f32 v51, v51
    v_exp_f32 v52, v52
    v_exp_f32 v53, v53
    v_smfmac_f32_32x32x32_bf16 v[76:91], v[140:143], v[44:51], v10
    v_exp_f32 v54, v54
    v_exp_f32 v55, v55
    v_exp_f32 v56, v56
    v_exp_f32 v57, v57
    v_exp_f32 v58, v58
    v_exp_f32 v59, v59
    v_exp_f32 v28, v28
    v_exp_f32 v29, v29
    v_smfmac_f32_32x32x32_bf16 v[76:91], v[144:147], v[52:59], v10
    v_exp_f32 v30, v30
    v_exp_f32 v31, v31
    v_exp_f32 v32, v32
    s_add_u32 s81, s95, 27
    s_and_b32 s81, s81, 31
    s_lshl_b32 s81, s81, 12
    s_add_u32 s75, s81, s74
    buffer_load_dwordx4 v[104:107], v19, s[44:47], s75 offen sc1
    s_mov_b64 exec, s[78:79]
    buffer_load_dwordx4 v[140:143], v9, s[44:47], s75 offen offset:1024 sc1
    buffer_load_dwordx4 v[144:147], v9, s[44:47], s75 offen offset:1536 sc1
    s_mov_b64 exec, -1
    v_mfma_f32_32x32x16_bf16 v[44:59], v[108:111], v[24:27], 0
    v_exp_f32 v33, v33
    v_exp_f32 v34, v34
    v_exp_f32 v35, v35
    v_exp_f32 v36, v36
    v_exp_f32 v37, v37
    v_smfmac_f32_32x32x32_bf16 v[60:75], v[148:151], v[28:35], v10
    v_exp_f32 v38, v38
    v_exp_f32 v39, v39
    v_exp_f32 v40, v40
    v_exp_f32 v41, v41
    v_exp_f32 v42, v42
    v_exp_f32 v43, v43
    v_exp_f32 v44, v44
    v_exp_f32 v45, v45
    v_smfmac_f32_32x32x32_bf16 v[60:75], v[152:155], v[36:43], v10
    v_exp_f32 v46, v46
    v_exp_f32 v47, v47
    v_exp_f32 v48, v48
    s_waitcnt vmcnt(12)
    v_mfma_f32_32x32x16_bf16 v[28:43], v[112:115], v[20:23], 0
    v_exp_f32 v49, v49
    v_exp_f32 v50, v50
    v_exp_f32 v51, v51
    v_exp_f32 v52, v52
    v_exp_f32 v53, v53
    v_smfmac_f32_32x32x32_bf16 v[76:91], v[148:151], v[44:51], v10
    v_exp_f32 v54, v54
    v_exp_f32 v55, v55
    v_exp_f32 v56, v56
    v_exp_f32 v57, v57
    v_exp_f32 v58, v58
    v_exp_f32 v59, v59
    v_exp_f32 v28, v28
    v_exp_f32 v29, v29
    v_smfmac_f32_32x32x32_bf16 v[76:91], v[152:155], v[52:59], v10
    v_exp_f32 v30, v30
    v_exp_f32 v31, v31
    v_exp_f32 v32, v32
    s_add_u32 s81, s95, 28
    s_and_b32 s81, s81, 31
    s_lshl_b32 s81, s81, 12
    s_add_u32 s75, s81, s74
    buffer_load_dwordx4 v[108:111], v19, s[44:47], s75 offen sc1
    s_mov_b64 exec, s[78:79]
    buffer_load_dwordx4 v[148:151], v9, s[44:47], s75 offen offset:1024 sc1
    buffer_load_dwordx4 v[152:155], v9, s[44:47], s75 offen offset:1536 sc1
    s_mov_b64 exec, -1
    v_mfma_f32_32x32x16_bf16 v[44:59], v[112:115], v[24:27], 0
    v_exp_f32 v33, v33
    v_exp_f32 v34, v34
    v_exp_f32 v35, v35
    v_exp_f32 v36, v36
    v_exp_f32 v37, v37
    v_smfmac_f32_32x32x32_bf16 v[60:75], v[156:159], v[28:35], v10
    v_exp_f32 v38, v38
    v_exp_f32 v39, v39
    v_exp_f32 v40, v40
    v_exp_f32 v41, v41
    v_exp_f32 v42, v42
    v_exp_f32 v43, v43
    v_exp_f32 v44, v44
    v_exp_f32 v45, v45
    v_smfmac_f32_32x32x32_bf16 v[60:75], v[160:163], v[36:43], v10
    v_exp_f32 v46, v46
    v_exp_f32 v47, v47
    v_exp_f32 v48, v48
    s_waitcnt vmcnt(12)
    v_mfma_f32_32x32x16_bf16 v[28:43], v[92:95], v[20:23], 0
    v_exp_f32 v49, v49
    v_exp_f32 v50, v50
    v_exp_f32 v51, v51
    v_exp_f32 v52, v52
    v_exp_f32 v53, v53
    v_smfmac_f32_32x32x32_bf16 v[76:91], v[156:159], v[44:51], v10
    v_exp_f32 v54, v54
    v_exp_f32 v55, v55
    v_exp_f32 v56, v56
    v_exp_f32 v57, v57
    v_exp_f32 v58, v58
    v_exp_f32 v59, v59
    v_exp_f32 v28, v28
    v_exp_f32 v29, v29
    v_smfmac_f32_32x32x32_bf16 v[76:91], v[160:163], v[52:59], v10
    v_exp_f32 v30, v30
    v_exp_f32 v31, v31
    v_exp_f32 v32, v32
    s_add_u32 s81, s95, 29
    s_and_b32 s81, s81, 31
    s_lshl_b32 s81, s81, 12
    s_add_u32 s75, s81, s74
    buffer_load_dwordx4 v[112:115], v19, s[44:47], s75 offen sc1
    s_mov_b64 exec, s[78:79]
    buffer_load_dwordx4 v[156:159], v9, s[44:47], s75 offen offset:1024 sc1
    buffer_load_dwordx4 v[160:163], v9, s[44:47], s75 offen offset:1536 sc1
    s_mov_b64 exec, -1
    v_mfma_f32_32x32x16_bf16 v[44:59], v[92:95], v[24:27], 0
    v_exp_f32 v33, v33
    v_exp_f32 v34, v34
    v_exp_f32 v35, v35
    v_exp_f32 v36, v36
    v_exp_f32 v37, v37
    v_smfmac_f32_32x32x32_bf16 v[60:75], v[116:119], v[28:35], v10
    v_exp_f32 v38, v38
    v_exp_f32 v39, v39
    v_exp_f32 v40, v40
    v_exp_f32 v41, v41
    v_exp_f32 v42, v42
    v_exp_f32 v43, v43
    v_exp_f32 v44, v44
    v_exp_f32 v45, v45
    v_smfmac_f32_32x32x32_bf16 v[60:75], v[120:123], v[36:43], v10
    v_exp_f32 v46, v46
    v_exp_f32 v47, v47
    v_exp_f32 v48, v48
    s_waitcnt vmcnt(12)
    v_mfma_f32_32x32x16_bf16 v[28:43], v[96:99], v[20:23], 0
    v_exp_f32 v49, v49
    v_exp_f32 v50, v50
    v_exp_f32 v51, v51
    v_exp_f32 v52, v52
    v_exp_f32 v53, v53
    v_smfmac_f32_32x32x32_bf16 v[76:91], v[116:119], v[44:51], v10
    v_exp_f32 v54, v54
    v_exp_f32 v55, v55
    v_exp_f32 v56, v56
    v_exp_f32 v57, v57
    v_exp_f32 v58, v58
    v_exp_f32 v59, v59
    v_exp_f32 v28, v28
    v_exp_f32 v29, v29
    v_smfmac_f32_32x32x32_bf16 v[76:91], v[120:123], v[52:59], v10
    v_exp_f32 v30, v30
    v_exp_f32 v31, v31
    v_exp_f32 v32, v32
    s_add_u32 s81, s95, 30
    s_and_b32 s81, s81, 31
    s_lshl_b32 s81, s81, 12
    s_add_u32 s75, s81, s74
    buffer_load_dwordx4 v[92:95], v19, s[44:47], s75 offen sc1
    s_mov_b64 exec, s[78:79]
    buffer_load_dwordx4 v[116:119], v9, s[44:47], s75 offen offset:1024 sc1
    buffer_load_dwordx4 v[120:123], v9, s[44:47], s75 offen offset:1536 sc1
    s_mov_b64 exec, -1
    v_mfma_f32_32x32x16_bf16 v[44:59], v[96:99], v[24:27], 0
    v_exp_f32 v33, v33
    v_exp_f32 v34, v34
    v_exp_f32 v35, v35
    v_exp_f32 v36, v36
    v_exp_f32 v37, v37
    v_smfmac_f32_32x32x32_bf16 v[60:75], v[124:127], v[28:35], v10
    v_exp_f32 v38, v38
    v_exp_f32 v39, v39
    v_exp_f32 v40, v40
    v_exp_f32 v41, v41
    v_exp_f32 v42, v42
    v_exp_f32 v43, v43
    v_exp_f32 v44, v44
    v_exp_f32 v45, v45
    v_smfmac_f32_32x32x32_bf16 v[60:75], v[128:131], v[36:43], v10
    v_exp_f32 v46, v46
    v_exp_f32 v47, v47
    v_exp_f32 v48, v48
    s_waitcnt vmcnt(12)
    v_mfma_f32_32x32x16_bf16 v[28:43], v[100:103], v[20:23], 0
    v_exp_f32 v49, v49
    v_exp_f32 v50, v50
    v_exp_f32 v51, v51
    v_exp_f32 v52, v52
    v_exp_f32 v53, v53
    v_smfmac_f32_32x32x32_bf16 v[76:91], v[124:127], v[44:51], v10
    v_exp_f32 v54, v54
    v_exp_f32 v55, v55
    v_exp_f32 v56, v56
    v_exp_f32 v57, v57
    v_exp_f32 v58, v58
    v_exp_f32 v59, v59
    v_exp_f32 v28, v28
    v_exp_f32 v29, v29
    v_smfmac_f32_32x32x32_bf16 v[76:91], v[128:131], v[52:59], v10
    v_exp_f32 v30, v30
    v_exp_f32 v31, v31
    v_exp_f32 v32, v32
    s_add_u32 s81, s95, 31
    s_and_b32 s81, s81, 31
    s_lshl_b32 s81, s81, 12
    s_add_u32 s75, s81, s74
    buffer_load_dwordx4 v[96:99], v19, s[44:47], s75 offen sc1
    s_mov_b64 exec, s[78:79]
    buffer_load_dwordx4 v[124:127], v9, s[44:47], s75 offen offset:1024 sc1
    buffer_load_dwordx4 v[128:131], v9, s[44:47], s75 offen offset:1536 sc1
    s_mov_b64 exec, -1
    v_mfma_f32_32x32x16_bf16 v[44:59], v[100:103], v[24:27], 0
    v_exp_f32 v33, v33
    v_exp_f32 v34, v34
    v_exp_f32 v35, v35
    v_exp_f32 v36, v36
    v_exp_f32 v37, v37
    v_smfmac_f32_32x32x32_bf16 v[60:75], v[132:135], v[28:35], v10
    v_exp_f32 v38, v38
    v_exp_f32 v39, v39
    v_exp_f32 v40, v40
    v_exp_f32 v41, v41
    v_exp_f32 v42, v42
    v_exp_f32 v43, v43
    v_exp_f32 v44, v44
    v_exp_f32 v45, v45
    v_smfmac_f32_32x32x32_bf16 v[60:75], v[136:139], v[36:43], v10
    v_exp_f32 v46, v46
    v_exp_f32 v47, v47
    v_exp_f32 v48, v48
    s_waitcnt vmcnt(12)
    v_mfma_f32_32x32x16_bf16 v[28:43], v[104:107], v[20:23], 0
    v_exp_f32 v49, v49
    v_exp_f32 v50, v50
    v_exp_f32 v51, v51
    v_exp_f32 v52, v52
    v_exp_f32 v53, v53
    v_smfmac_f32_32x32x32_bf16 v[76:91], v[132:135], v[44:51], v10
    v_exp_f32 v54, v54
    v_exp_f32 v55, v55
    v_exp_f32 v56, v56
    v_exp_f32 v57, v57
    v_exp_f32 v58, v58
    v_exp_f32 v59, v59
    v_exp_f32 v28, v28
    v_exp_f32 v29, v29
    v_smfmac_f32_32x32x32_bf16 v[76:91], v[136:139], v[52:59], v10
    v_exp_f32 v30, v30
    v_exp_f32 v31, v31
    v_exp_f32 v32, v32
    v_mfma_f32_32x32x16_bf16 v[44:59], v[104:107], v[24:27], 0
    v_exp_f32 v33, v33
    v_exp_f32 v34, v34
    v_exp_f32 v35, v35
    v_exp_f32 v36, v36
    v_exp_f32 v37, v37
    v_smfmac_f32_32x32x32_bf16 v[60:75], v[140:143], v[28:35], v10
    v_exp_f32 v38, v38
    v_exp_f32 v39, v39
    v_exp_f32 v40, v40
    v_exp_f32 v41, v41
    v_exp_f32 v42, v42
    v_exp_f32 v43, v43
    v_exp_f32 v44, v44
    v_exp_f32 v45, v45
    v_smfmac_f32_32x32x32_bf16 v[60:75], v[144:147], v[36:43], v10
    v_exp_f32 v46, v46
    v_exp_f32 v47, v47
    v_exp_f32 v48, v48
    s_waitcnt vmcnt(9)
    v_mfma_f32_32x32x16_bf16 v[28:43], v[108:111], v[20:23], 0
    v_exp_f32 v49, v49
    v_exp_f32 v50, v50
    v_exp_f32 v51, v51
    v_exp_f32 v52, v52
    v_exp_f32 v53, v53
    v_smfmac_f32_32x32x32_bf16 v[76:91], v[140:143], v[44:51], v10
    v_exp_f32 v54, v54
    v_exp_f32 v55, v55
    v_exp_f32 v56, v56
    v_exp_f32 v57, v57
    v_exp_f32 v58, v58
    v_exp_f32 v59, v59
    v_exp_f32 v28, v28
    v_exp_f32 v29, v29
    v_smfmac_f32_32x32x32_bf16 v[76:91], v[144:147], v[52:59], v10
    v_exp_f32 v30, v30
    v_exp_f32 v31, v31
    v_exp_f32 v32, v32
    s_setprio 0
    v_mfma_f32_32x32x16_bf16 v[44:59], v[108:111], v[24:27], 0
    v_exp_f32 v33, v33
    v_exp_f32 v34, v34
    v_exp_f32 v35, v35
    v_exp_f32 v36, v36
    v_exp_f32 v37, v37
    v_smfmac_f32_32x32x32_bf16 v[60:75], v[148:151], v[28:35], v10
    v_exp_f32 v38, v38
    v_exp_f32 v39, v39
    v_exp_f32 v40, v40
    v_exp_f32 v41, v41
    v_exp_f32 v42, v42
    v_exp_f32 v43, v43
    v_exp_f32 v44, v44
    v_exp_f32 v45, v45
    v_smfmac_f32_32x32x32_bf16 v[60:75], v[152:155], v[36:43], v10
    v_exp_f32 v46, v46
    v_exp_f32 v47, v47
    v_exp_f32 v48, v48
    s_waitcnt vmcnt(6)
    v_mfma_f32_32x32x16_bf16 v[28:43], v[112:115], v[20:23], 0
    v_exp_f32 v49, v49
    v_exp_f32 v50, v50
    v_exp_f32 v51, v51
    v_exp_f32 v52, v52
    v_exp_f32 v53, v53
    v_smfmac_f32_32x32x32_bf16 v[76:91], v[148:151], v[44:51], v10
    v_exp_f32 v54, v54
    v_exp_f32 v55, v55
    v_exp_f32 v56, v56
    v_exp_f32 v57, v57
    v_exp_f32 v58, v58
    v_exp_f32 v59, v59
    v_exp_f32 v28, v28
    v_exp_f32 v29, v29
    v_smfmac_f32_32x32x32_bf16 v[76:91], v[152:155], v[52:59], v10
    v_exp_f32 v30, v30
    v_exp_f32 v31, v31
    v_exp_f32 v32, v32
    v_mfma_f32_32x32x16_bf16 v[44:59], v[112:115], v[24:27], 0
    v_exp_f32 v33, v33
    v_exp_f32 v34, v34
    v_exp_f32 v35, v35
    v_exp_f32 v36, v36
    v_exp_f32 v37, v37
    v_smfmac_f32_32x32x32_bf16 v[60:75], v[156:159], v[28:35], v10
    v_exp_f32 v38, v38
    v_exp_f32 v39, v39
    v_exp_f32 v40, v40
    v_exp_f32 v41, v41
    v_exp_f32 v42, v42
    v_exp_f32 v43, v43
    v_exp_f32 v44, v44
    v_exp_f32 v45, v45
    v_smfmac_f32_32x32x32_bf16 v[60:75], v[160:163], v[36:43], v10
    v_exp_f32 v46, v46
    v_exp_f32 v47, v47
    v_exp_f32 v48, v48
    s_waitcnt vmcnt(3)
    v_mfma_f32_32x32x16_bf16 v[28:43], v[92:95], v[20:23], 0
    v_exp_f32 v49, v49
    v_exp_f32 v50, v50
    v_exp_f32 v51, v51
    v_exp_f32 v52, v52
    v_exp_f32 v53, v53
    v_smfmac_f32_32x32x32_bf16 v[76:91], v[156:159], v[44:51], v10
    v_exp_f32 v54, v54
    v_exp_f32 v55, v55
    v_exp_f32 v56, v56
    v_exp_f32 v57, v57
    v_exp_f32 v58, v58
    v_exp_f32 v59, v59
    v_exp_f32 v28, v28
    v_exp_f32 v29, v29
    v_smfmac_f32_32x32x32_bf16 v[76:91], v[160:163], v[52:59], v10
    v_exp_f32 v30, v30
    v_exp_f32 v31, v31
    v_exp_f32 v32, v32
    v_mfma_f32_32x32x16_bf16 v[44:59], v[92:95], v[24:27], 0
    v_exp_f32 v33, v33
    v_exp_f32 v34, v34
    v_exp_f32 v35, v35
    v_exp_f32 v36, v36
    v_exp_f32 v37, v37
    v_smfmac_f32_32x32x32_bf16 v[60:75], v[116:119], v[28:35], v10
    v_exp_f32 v38, v38
    v_exp_f32 v39, v39
    v_exp_f32 v40, v40
    v_exp_f32 v41, v41
    v_exp_f32 v42, v42
    v_exp_f32 v43, v43
    v_exp_f32 v44, v44
    v_exp_f32 v45, v45
    v_smfmac_f32_32x32x32_bf16 v[60:75], v[120:123], v[36:43], v10
    v_exp_f32 v46, v46
    v_exp_f32 v47, v47
    v_exp_f32 v48, v48
    s_waitcnt vmcnt(0)
    v_mfma_f32_32x32x16_bf16 v[28:43], v[96:99], v[20:23], 0
    v_exp_f32 v49, v49
    v_exp_f32 v50, v50
    v_exp_f32 v51, v51
    v_exp_f32 v52, v52
    v_exp_f32 v53, v53
    v_smfmac_f32_32x32x32_bf16 v[76:91], v[116:119], v[44:51], v10
    v_exp_f32 v54, v54
    v_exp_f32 v55, v55
    v_exp_f32 v56, v56
    v_exp_f32 v57, v57
    v_exp_f32 v58, v58
    v_exp_f32 v59, v59
    v_exp_f32 v28, v28
    v_exp_f32 v29, v29
    v_smfmac_f32_32x32x32_bf16 v[76:91], v[120:123], v[52:59], v10
    v_exp_f32 v30, v30
    v_exp_f32 v31, v31
    v_exp_f32 v32, v32
    v_mfma_f32_32x32x16_bf16 v[44:59], v[96:99], v[24:27], 0
    v_exp_f32 v33, v33
    v_exp_f32 v34, v34
    v_exp_f32 v35, v35
    v_exp_f32 v36, v36
    v_exp_f32 v37, v37
    v_smfmac_f32_32x32x32_bf16 v[60:75], v[124:127], v[28:35], v10
    v_exp_f32 v38, v38
    v_exp_f32 v39, v39
    v_exp_f32 v40, v40
    v_exp_f32 v41, v41
    v_exp_f32 v42, v42
    v_exp_f32 v43, v43
    v_exp_f32 v44, v44
    v_exp_f32 v45, v45
    v_smfmac_f32_32x32x32_bf16 v[60:75], v[128:131], v[36:43], v10
    v_exp_f32 v46, v46
    v_exp_f32 v47, v47
    v_exp_f32 v48, v48
    v_exp_f32 v49, v49
    v_exp_f32 v50, v50
    v_exp_f32 v51, v51
    v_exp_f32 v52, v52
    v_exp_f32 v53, v53
    v_smfmac_f32_32x32x32_bf16 v[76:91], v[124:127], v[44:51], v10
    v_exp_f32 v54, v54
    v_exp_f32 v55, v55
    v_exp_f32 v56, v56
    v_exp_f32 v57, v57
    v_exp_f32 v58, v58
    v_exp_f32 v59, v59
    s_nop 1
    v_smfmac_f32_32x32x32_bf16 v[76:91], v[128:131], v[52:59], v10
    s_setprio 3
    s_mul_i32 s68, s22, 2304
    s_add_u32 s68, s68, 131072
    v_add_u32 v44, s68, v8
    v_lshlrev_b32 v45, 2, v0
    v_add_u32 v45, s68, v45
    s_xor_b32 s69, s22, 1
    s_mul_i32 s69, s69, 2304
    s_add_u32 s69, s69, 131072
    v_add_u32 v18, s69, v8
    v_lshlrev_b32 v47, 2, v0
    v_add_u32 v47, s69, v47
    ds_write_b128 v44, v[76:79]
    ds_write_b128 v44, v[80:83] offset:1024
    ds_write_b32 v45, v84 offset:2048
    v_bfe_u32 v48, v0, 4, 1
    v_lshlrev_b32 v48, 14, v48
    v_add_u32 v48, v48, v9
    s_and_b32 s68, s71, 1
    s_lshl_b32 s68, s68, 9
    v_add_u32 v48, s68, v48
    s_waitcnt lgkmcnt(0)
    s_barrier
    ds_read_b32 v36, v47 offset:2048
    ds_read_b128 v[28:31], v18
    ds_read_b128 v[32:35], v18 offset:1024
    s_waitcnt lgkmcnt(2)
    v_add_f32 v68, v68, v36
    v_cmp_nle_f32 vcc, s85, v68
    v_cmp_nge_f32 s[88:89], s86, v68
    s_waitcnt lgkmcnt(1)
    v_add_f32 v60, v60, v28
    v_add_f32 v61, v61, v29
    v_add_f32 v62, v62, v30
    v_add_f32 v63, v63, v31
    s_waitcnt lgkmcnt(0)
    v_add_f32 v64, v64, v32
    v_add_f32 v65, v65, v33
    v_add_f32 v66, v66, v34
    v_add_f32 v67, v67, v35
    s_or_b64 vcc, vcc, s[88:89]
    s_cmp_lg_u64 vcc, 0
    s_cbranch_scc1 L_fallback
L_norm:
    v_rcp_f32 v37, v68
    s_nop 0
    v_mul_f32 v60, v60, v37
    v_mul_f32 v61, v61, v37
    v_mul_f32 v62, v62, v37
    v_mul_f32 v63, v63, v37
    v_mul_f32 v64, v64, v37
    v_mul_f32 v65, v65, v37
    v_mul_f32 v66, v66, v37
    v_mul_f32 v67, v67, v37
    v_cvt_pk_bf16_f32 v28, v60, v61
    v_cvt_pk_bf16_f32 v29, v62, v63
    v_cvt_pk_bf16_f32 v30, v64, v65
    v_cvt_pk_bf16_f32 v31, v66, v67
    buffer_store_dwordx4 v[28:31], v48, s[44:47], s66 offen sc1
    v_lshrrev_b32 v4, 2, v0
    v_and_b32 v4, 7, v4
    v_lshrrev_b32 v5, 5, v0
    v_lshl_add_u32 v5, v5, 4, v4
    v_lshlrev_b32 v5, 7, v5
    v_and_b32 v4, 6, v4
    v_bfe_u32 v2, v0, 1, 1
    v_xor_b32 v4, v4, v2
    v_lshl_add_u32 v5, v4, 4, v5
    v_and_b32 v4, 1, v0
    v_lshl_add_u32 v2, v4, 3, v5
    s_lshr_b32 s70, s22, 2
    s_lshl_b32 s68, s70, 15
    s_lshl_b32 s69, s70, 6
    v_add_u32 v2, s68, v2
    v_xor_b32 v2, s69, v2
    v_xor_b32 v3, 32, v2
    v_xor_b32 v6, 64, v2
    v_xor_b32 v7, 96, v2
    ds_read_b64_tr_b16 v[52:53], v2 offset:0
    ds_read_b64_tr_b16 v[54:55], v2 offset:1024
    ds_read_b64_tr_b16 v[56:57], v3 offset:0
    ds_read_b64_tr_b16 v[58:59], v3 offset:1024
    ds_read_b64_tr_b16 v[60:61], v6 offset:0
    ds_read_b64_tr_b16 v[62:63], v6 offset:1024
    ds_read_b64_tr_b16 v[64:65], v7 offset:0
    ds_read_b64_tr_b16 v[66:67], v7 offset:1024
    v_and_b32 v11, 15, v0
    v_lshlrev_b32 v17, 11, v11
    v_lshlrev_b32 v11, 7, v11
    v_lshrrev_b32 v4, 4, v0
    v_lshl_add_u32 v17, v4, 3, v17
    s_xor_b32 s69, s22, 5
    s_mul_i32 s69, s69, 2304
    s_add_u32 s69, s69, 131072
    v_add_u32 v19, s69, v8
    s_waitcnt lgkmcnt(0)
    ds_read_b64_tr_b16 v[68:69], v2 offset:4096
    ds_read_b64_tr_b16 v[70:71], v2 offset:5120
    ds_read_b64_tr_b16 v[72:73], v3 offset:4096
    ds_read_b64_tr_b16 v[74:75], v3 offset:5120
    ds_read_b64_tr_b16 v[76:77], v6 offset:4096
    ds_read_b64_tr_b16 v[78:79], v6 offset:5120
    ds_read_b64_tr_b16 v[80:81], v7 offset:4096
    ds_read_b64_tr_b16 v[82:83], v7 offset:5120
    v_mov_b32 v4, 155648
    v_mov_b32 v5, 1
    s_waitcnt vmcnt(0)
    s_mov_b64 exec, 1
    ds_add_rtn_u32 v12, v4, v5 offset:40
    s_mov_b64 exec, -1
    s_waitcnt lgkmcnt(0)
    v_readfirstlane_b32 s68, v12
    s_cmp_lg_u32 s68, 7
    s_cbranch_scc1 L_nl1
    s_mov_b64 exec, 1
    buffer_store_dwordx2 v[14:15], v16, s[44:47], s67 offen sc1
    s_mov_b64 exec, -1
L_nl1:
    s_waitcnt lgkmcnt(0)
    ds_read_b64_tr_b16 v[84:85], v2 offset:8192
    ds_read_b64_tr_b16 v[86:87], v2 offset:9216
    ds_read_b64_tr_b16 v[88:89], v3 offset:8192
    ds_read_b64_tr_b16 v[90:91], v3 offset:9216
    ds_read_b64_tr_b16 v[92:93], v6 offset:8192
    ds_read_b64_tr_b16 v[94:95], v6 offset:9216
    ds_read_b64_tr_b16 v[96:97], v7 offset:8192
    ds_read_b64_tr_b16 v[98:99], v7 offset:9216
    s_waitcnt lgkmcnt(0)
    ds_read_b64_tr_b16 v[100:101], v2 offset:12288
    ds_read_b64_tr_b16 v[102:103], v2 offset:13312
    ds_read_b64_tr_b16 v[104:105], v3 offset:12288
    ds_read_b64_tr_b16 v[106:107], v3 offset:13312
    ds_read_b64_tr_b16 v[108:109], v6 offset:12288
    ds_read_b64_tr_b16 v[110:111], v6 offset:13312
    ds_read_b64_tr_b16 v[112:113], v7 offset:12288
    ds_read_b64_tr_b16 v[114:115], v7 offset:13312
    s_waitcnt lgkmcnt(0)
    ds_read_b64_tr_b16 v[116:117], v2 offset:16384
    ds_read_b64_tr_b16 v[118:119], v2 offset:17408
    ds_read_b64_tr_b16 v[120:121], v3 offset:16384
    ds_read_b64_tr_b16 v[122:123], v3 offset:17408
    ds_read_b64_tr_b16 v[124:125], v6 offset:16384
    ds_read_b64_tr_b16 v[126:127], v6 offset:17408
    ds_read_b64_tr_b16 v[128:129], v7 offset:16384
    ds_read_b64_tr_b16 v[130:131], v7 offset:17408
    s_waitcnt lgkmcnt(0)
    ds_read_b64_tr_b16 v[132:133], v2 offset:20480
    ds_read_b64_tr_b16 v[134:135], v2 offset:21504
    ds_read_b64_tr_b16 v[136:137], v3 offset:20480
    ds_read_b64_tr_b16 v[138:139], v3 offset:21504
    ds_read_b64_tr_b16 v[140:141], v6 offset:20480
    ds_read_b64_tr_b16 v[142:143], v6 offset:21504
    ds_read_b64_tr_b16 v[144:145], v7 offset:20480
    ds_read_b64_tr_b16 v[146:147], v7 offset:21504
    s_waitcnt lgkmcnt(0)
    s_lshr_b32 s69, s22, 2
    s_lshl_b32 s70, s69, 9
    s_add_u32 s63, s63, s70
    s_lshl_b32 s69, s69, 4
    v_add_u32 v4, s69, v4
    s_and_b32 s68, s22, 3
    s_cmp_lg_u32 s68, 0
    s_cbranch_scc1 L_nl2
    s_mov_b64 exec, 0xf
    s_mov_b32 s80, 0
    buffer_load_dwordx2 v[148:149], v11, s[44:47], s63 offen sc1
    buffer_load_dwordx2 v[150:151], v11, s[44:47], s63 offen sc1
    buffer_load_dwordx2 v[152:153], v11, s[44:47], s63 offen sc1
L_pp_7:
    s_waitcnt vmcnt(2)
    v_cmp_eq_u64 vcc, s[76:77], v[148:149]
    s_cmp_eq_u64 vcc, exec
    s_cbranch_scc1 L_ppd_8
    buffer_load_dwordx2 v[148:149], v11, s[44:47], s63 offen sc1
    s_waitcnt vmcnt(2)
    v_cmp_eq_u64 vcc, s[76:77], v[150:151]
    s_cmp_eq_u64 vcc, exec
    s_cbranch_scc1 L_ppd_8
    buffer_load_dwordx2 v[150:151], v11, s[44:47], s63 offen sc1
    s_waitcnt vmcnt(2)
    v_cmp_eq_u64 vcc, s[76:77], v[152:153]
    s_cmp_eq_u64 vcc, exec
    s_cbranch_scc1 L_ppd_8
    buffer_load_dwordx2 v[152:153], v11, s[44:47], s63 offen sc1
    s_add_u32 s80, s80, 1
    s_cmp_le_u32 s80, 30000
    s_cbranch_scc1 L_pp_7
L_ppd_8:
    s_mov_b64 exec, -1
    ds_write_b32 v4, v5 offset:36
    s_branch L_nl3
L_nl2:
    s_mov_b32 s80, 0
L_ws_9:
    ds_read_b32 v12, v4 offset:36
    s_add_u32 s80, s80, 1
    s_waitcnt lgkmcnt(0)
    v_readfirstlane_b32 s69, v12
    s_cmp_gt_u32 s80, 240000
    s_cbranch_scc1 L_wsd_10
    s_cmp_eq_u32 s69, 0
    s_cbranch_scc1 L_ws_9
L_wsd_10:
L_nl3:
    buffer_load_dwordx4 v[20:23], v8, s[44:47], s64 offen offset:0 sc1
    buffer_load_dwordx4 v[24:27], v8, s[44:47], s64 offen offset:1024 sc1
    buffer_load_dwordx4 v[28:31], v8, s[44:47], s64 offen offset:2048 sc1
    buffer_load_dwordx4 v[32:35], v8, s[44:47], s64 offen offset:3072 sc1
    s_add_u32 s64, s64, 4096
    buffer_load_dwordx4 v[36:39], v8, s[44:47], s64 offen offset:0 sc1
    buffer_load_dwordx4 v[40:43], v8, s[44:47], s64 offen offset:1024 sc1
    buffer_load_dwordx4 v[44:47], v8, s[44:47], s64 offen offset:2048 sc1
    buffer_load_dwordx4 v[48:51], v8, s[44:47], s64 offen offset:3072 sc1
    s_waitcnt lgkmcnt(0)
    s_waitcnt vmcnt(7)
    v_mfma_f32_16x16x32_bf16 v[148:151], v[52:55], v[20:23], 0
    v_mfma_f32_16x16x32_bf16 v[152:155], v[56:59], v[20:23], 0
    v_mfma_f32_16x16x32_bf16 v[156:159], v[60:63], v[20:23], 0
    v_mfma_f32_16x16x32_bf16 v[160:163], v[64:67], v[20:23], 0
    s_waitcnt lgkmcnt(0)
    ds_read_b64_tr_b16 v[52:53], v2 offset:24576
    ds_read_b64_tr_b16 v[54:55], v2 offset:25600
    ds_read_b64_tr_b16 v[56:57], v3 offset:24576
    ds_read_b64_tr_b16 v[58:59], v3 offset:25600
    ds_read_b64_tr_b16 v[60:61], v6 offset:24576
    ds_read_b64_tr_b16 v[62:63], v6 offset:25600
    ds_read_b64_tr_b16 v[64:65], v7 offset:24576
    ds_read_b64_tr_b16 v[66:67], v7 offset:25600
    s_waitcnt vmcnt(6)
    v_mfma_f32_16x16x32_bf16 v[148:151], v[68:71], v[24:27], v[148:151]
    v_mfma_f32_16x16x32_bf16 v[152:155], v[72:75], v[24:27], v[152:155]
    v_mfma_f32_16x16x32_bf16 v[156:159], v[76:79], v[24:27], v[156:159]
    v_mfma_f32_16x16x32_bf16 v[160:163], v[80:83], v[24:27], v[160:163]
    s_waitcnt lgkmcnt(0)
    ds_read_b64_tr_b16 v[68:69], v2 offset:28672
    ds_read_b64_tr_b16 v[70:71], v2 offset:29696
    ds_read_b64_tr_b16 v[72:73], v3 offset:28672
    ds_read_b64_tr_b16 v[74:75], v3 offset:29696
    ds_read_b64_tr_b16 v[76:77], v6 offset:28672
    ds_read_b64_tr_b16 v[78:79], v6 offset:29696
    ds_read_b64_tr_b16 v[80:81], v7 offset:28672
    ds_read_b64_tr_b16 v[82:83], v7 offset:29696
    s_waitcnt vmcnt(5)
    v_mfma_f32_16x16x32_bf16 v[148:151], v[84:87], v[28:31], v[148:151]
    v_mfma_f32_16x16x32_bf16 v[152:155], v[88:91], v[28:31], v[152:155]
    v_mfma_f32_16x16x32_bf16 v[156:159], v[92:95], v[28:31], v[156:159]
    v_mfma_f32_16x16x32_bf16 v[160:163], v[96:99], v[28:31], v[160:163]
    s_waitcnt vmcnt(4)
    v_mfma_f32_16x16x32_bf16 v[148:151], v[100:103], v[32:35], v[148:151]
    v_mfma_f32_16x16x32_bf16 v[152:155], v[104:107], v[32:35], v[152:155]
    v_mfma_f32_16x16x32_bf16 v[156:159], v[108:111], v[32:35], v[156:159]
    v_mfma_f32_16x16x32_bf16 v[160:163], v[112:115], v[32:35], v[160:163]
    s_waitcnt vmcnt(3)
    v_mfma_f32_16x16x32_bf16 v[148:151], v[116:119], v[36:39], v[148:151]
    v_mfma_f32_16x16x32_bf16 v[152:155], v[120:123], v[36:39], v[152:155]
    v_mfma_f32_16x16x32_bf16 v[156:159], v[124:127], v[36:39], v[156:159]
    v_mfma_f32_16x16x32_bf16 v[160:163], v[128:131], v[36:39], v[160:163]
    s_waitcnt vmcnt(2)
    v_mfma_f32_16x16x32_bf16 v[148:151], v[132:135], v[40:43], v[148:151]
    v_mfma_f32_16x16x32_bf16 v[152:155], v[136:139], v[40:43], v[152:155]
    v_mfma_f32_16x16x32_bf16 v[156:159], v[140:143], v[40:43], v[156:159]
    v_mfma_f32_16x16x32_bf16 v[160:163], v[144:147], v[40:43], v[160:163]
    s_waitcnt vmcnt(1)
    v_mfma_f32_16x16x32_bf16 v[148:151], v[52:55], v[44:47], v[148:151]
    v_mfma_f32_16x16x32_bf16 v[152:155], v[56:59], v[44:47], v[152:155]
    v_mfma_f32_16x16x32_bf16 v[156:159], v[60:63], v[44:47], v[156:159]
    v_mfma_f32_16x16x32_bf16 v[160:163], v[64:67], v[44:47], v[160:163]
    s_waitcnt vmcnt(0)
    s_waitcnt lgkmcnt(0)
    v_mfma_f32_16x16x32_bf16 v[148:151], v[68:71], v[48:51], v[148:151]
    v_mfma_f32_16x16x32_bf16 v[152:155], v[72:75], v[48:51], v[152:155]
    v_mfma_f32_16x16x32_bf16 v[156:159], v[76:79], v[48:51], v[156:159]
    v_mfma_f32_16x16x32_bf16 v[160:163], v[80:83], v[48:51], v[160:163]
    s_nop 7
    ds_write_b128 v18, v[156:159]
    ds_write_b128 v18, v[160:163] offset:1024
    s_waitcnt lgkmcnt(0)
    s_barrier
    ds_read_b128 v[156:159], v19
    ds_read_b128 v[160:163], v19 offset:1024
    s_waitcnt lgkmcnt(1)
    v_add_f32 v148, v148, v156
    v_add_f32 v149, v149, v157
    v_add_f32 v150, v150, v158
    v_add_f32 v151, v151, v159
    v_cvt_pk_bf16_f32 v148, v148, v149
    v_cvt_pk_bf16_f32 v149, v150, v151
    buffer_store_dwordx2 v[148:149], v17, s[56:59], s65 offen offset:0
    s_waitcnt lgkmcnt(0)
    v_add_f32 v152, v152, v160
    v_add_f32 v153, v153, v161
    v_add_f32 v154, v154, v162
    v_add_f32 v155, v155, v163
    v_cvt_pk_bf16_f32 v152, v152, v153
    v_cvt_pk_bf16_f32 v153, v154, v155
    buffer_store_dwordx2 v[152:153], v17, s[56:59], s65 offen offset:32
    s_endpgm
L_fallback:
    s_lshl_b32 s68, s72, 11
    s_sub_u32 s70, s74, s68
    s_mov_b32 s75, s70
    s_mov_b32 s80, 0
    v_mov_b32 v4, 0xf149f2ca
L_fb1:
    buffer_load_dwordx4 v[108:111], v19, s[44:47], s75 offen sc1
    s_waitcnt vmcnt(0)
    v_mfma_f32_32x32x16_bf16 v[92:107], v[108:111], v[20:23], 0
    s_add_u32 s75, s75, 2048
    s_add_u32 s80, s80, 1
    s_nop 11
    v_max3_f32 v4, v4, v92, v93
    v_max3_f32 v4, v4, v94, v95
    v_max3_f32 v4, v4, v96, v97
    v_max3_f32 v4, v4, v98, v99
    v_max3_f32 v4, v4, v100, v101
    v_max3_f32 v4, v4, v102, v103
    v_max3_f32 v4, v4, v104, v105
    v_max3_f32 v4, v4, v106, v107
    s_cmp_lt_u32 s80, 64
    s_cbranch_scc1 L_fb1
    v_mov_b32 v5, v4
    s_nop 1
    v_permlane32_swap_b32 v4, v5
    s_nop 1
    v_max_f32 v4, v4, v5
    v_sub_f32 v76, 0, v4
    v_sub_f32 v77, 0, v4
    v_sub_f32 v78, 0, v4
    v_sub_f32 v79, 0, v4
    v_sub_f32 v80, 0, v4
    v_sub_f32 v81, 0, v4
    v_sub_f32 v82, 0, v4
    v_sub_f32 v83, 0, v4
    v_sub_f32 v84, 0, v4
    v_sub_f32 v85, 0, v4
    v_sub_f32 v86, 0, v4
    v_sub_f32 v87, 0, v4
    v_sub_f32 v88, 0, v4
    v_sub_f32 v89, 0, v4
    v_sub_f32 v90, 0, v4
    v_sub_f32 v91, 0, v4
    v_mov_b32 v60, 0
    v_mov_b32 v61, 0
    v_mov_b32 v62, 0
    v_mov_b32 v63, 0
    v_mov_b32 v64, 0
    v_mov_b32 v65, 0
    v_mov_b32 v66, 0
    v_mov_b32 v67, 0
    v_mov_b32 v68, 0
    v_mov_b32 v69, 0
    v_mov_b32 v70, 0
    v_mov_b32 v71, 0
    v_mov_b32 v72, 0
    v_mov_b32 v73, 0
    v_mov_b32 v74, 0
    v_mov_b32 v75, 0
    s_mov_b32 s75, s70
    s_mov_b32 s80, 0
L_fb2:
    buffer_load_dwordx4 v[108:111], v19, s[44:47], s75 offen sc1
    s_mov_b64 exec, s[78:79]
    buffer_load_dwordx4 v[116:119], v9, s[44:47], s75 offen offset:1024 sc1
    buffer_load_dwordx4 v[120:123], v9, s[44:47], s75 offen offset:1536 sc1
    s_mov_b64 exec, -1
    s_waitcnt vmcnt(0)
    v_mfma_f32_32x32x16_bf16 v[92:107], v[108:111], v[20:23], v[76:91]
    s_add_u32 s75, s75, 2048
    s_add_u32 s80, s80, 1
    s_nop 11
    v_exp_f32 v92, v92
    v_exp_f32 v93, v93
    v_exp_f32 v94, v94
    v_exp_f32 v95, v95
    v_exp_f32 v96, v96
    v_exp_f32 v97, v97
    v_exp_f32 v98, v98
    v_exp_f32 v99, v99
    v_exp_f32 v100, v100
    v_exp_f32 v101, v101
    v_exp_f32 v102, v102
    v_exp_f32 v103, v103
    v_exp_f32 v104, v104
    v_exp_f32 v105, v105
    v_exp_f32 v106, v106
    v_exp_f32 v107, v107
    s_nop 1
    v_smfmac_f32_32x32x32_bf16 v[60:75], v[116:119], v[92:99], v10
    v_smfmac_f32_32x32x32_bf16 v[60:75], v[120:123], v[100:107], v10
    s_cmp_lt_u32 s80, 64
    s_cbranch_scc1 L_fb2
    s_nop 15
    s_branch L_norm
L_aux:
    s_setprio 3
    s_sub_u32 s60, s22, 8
    s_and_b32 s82, s60, 1
    s_lshr_b32 s83, s60, 1
    v_mov_b32 v5, 0
    s_waitcnt lgkmcnt(0)
    s_mov_b32 s44, s20
    s_mov_b32 s45, s21
    s_mov_b32 s46, 33554432
    s_mov_b32 s47, 0x00020000
    s_mov_b32 s48, s18
    s_mov_b32 s49, s19
    s_mov_b32 s50, 256
    s_mov_b32 s51, 0x00020000
    s_barrier
    s_add_u32 s62, s2, s60
    s_cmp_lg_u32 s62, 0
    s_cbranch_scc1 L_nonon
    s_mov_b32 s62, 8454144
    s_mov_b64 exec, 1
    buffer_load_dwordx2 v[6:7], v5, s[44:47], s62 offen sc1
    s_waitcnt vmcnt(0)
    v_add_u32 v6, 2, v6
    v_or_b32 v6, 1, v6
    v_or_b32 v7, 0x80000000, v7
    buffer_store_dwordx2 v[6:7], v5, s[48:51], 0 offen sc1
    buffer_store_dwordx2 v[6:7], v5, s[44:47], s62 offen sc1
    s_mov_b64 exec, -1
L_nonon:
    v_mov_b32 v24, 155648
    v_lshl_add_u32 v2, v0, 2, v24
    ds_write_b32 v2, v5
    v_and_b32 v2, 31, v0
    v_lshrrev_b32 v3, 5, v0
    v_bfe_u32 v4, v0, 1, 3
    v_xor_b32 v4, v4, v3
    v_lshlrev_b32 v4, 4, v4
    v_lshl_add_u32 v4, v2, 7, v4
    s_lshl_b32 s62, s82, 13
    s_add_u32 s62, s62, 24576
    v_add_u32 v10, s62, v4
    v_xor_b32 v11, 32, v10
    v_xor_b32 v12, 64, v10
    v_xor_b32 v13, 96, v10
    v_add_u32 v14, 81920, v10
    v_add_u32 v15, 81920, v11
    v_add_u32 v16, 81920, v12
    v_add_u32 v17, 81920, v13
    v_bfe_u32 v4, v0, 2, 2
    v_lshl_add_u32 v4, v3, 3, v4
    v_lshlrev_b32 v4, 7, v4
    v_bfe_u32 v21, v0, 4, 1
    v_lshl_add_u32 v4, v21, 5, v4
    v_and_b32 v18, 3, v0
    v_lshl_add_u32 v4, v18, 3, v4
    v_bfe_u32 v18, v0, 3, 1
    v_lshl_add_u32 v18, v18, 6, v4
    s_lshl_b32 s62, s83, 6
    v_xor_b32 v18, s62, v18
    v_add_u32 v19, 81920, v18
    v_and_b32 v20, 0x33, v0
    v_bfe_u32 v4, v0, 2, 1
    v_lshl_add_u32 v20, v4, 3, v20
    v_bfe_u32 v4, v0, 3, 1
    v_lshl_add_u32 v20, v4, 2, v20
    v_lshlrev_b32 v20, 4, v20
    v_and_b32 v4, 15, v0
    v_lshlrev_b32 v4, 4, v4
    v_lshl_add_u32 v9, v3, 8, v4
    v_lshlrev_b32 v8, 4, v0
    s_mov_b32 s84, 0x3eb8aa3b
    s_mov_b32 s85, 0x3eb8aa3b
    s_mov_b32 s68, 0x0000ffff
    s_mov_b32 s69, 0x0000ffff
    s_lshl_b32 s78, s27, 1
    s_add_u32 s78, s78, s82
    s_lshl_b32 s78, s78, 1
    s_lshl_b32 s77, s3, 4
    s_add_u32 s77, s77, s27
    s_waitcnt lgkmcnt(0)
    s_barrier
    ds_read_b128 v[124:127], v10 offset:40960
    ds_read_b64_tr_b16 v[140:141], v18 offset:49152
    ds_read_b64_tr_b16 v[142:143], v18 offset:49664
    ds_read_b128 v[128:131], v10 offset:45056
    ds_read_b64_tr_b16 v[144:145], v18 offset:57344
    ds_read_b64_tr_b16 v[146:147], v18 offset:57856
    ds_read_b64_tr_b16 v[148:149], v18 offset:40960
    ds_read_b64_tr_b16 v[150:151], v18 offset:41472
    s_waitcnt lgkmcnt(5)
    v_mfma_f32_32x32x16_bf16 v[28:43], v[140:143], v[124:127], 0
    ds_read_b128 v[132:135], v11 offset:40960
    s_waitcnt lgkmcnt(5)
    v_mfma_f32_32x32x16_bf16 v[44:59], v[140:143], v[128:131], 0
    ds_read_b64_tr_b16 v[140:141], v18 offset:51200
    ds_read_b64_tr_b16 v[142:143], v18 offset:51712
    s_waitcnt lgkmcnt(5)
    v_mfma_f32_32x32x16_bf16 v[60:75], v[124:127], v[144:147], 0
    ds_read_b128 v[136:139], v11 offset:45056
    v_mfma_f32_32x32x16_bf16 v[76:91], v[128:131], v[144:147], 0
    ds_read_b64_tr_b16 v[144:145], v18 offset:59392
    ds_read_b64_tr_b16 v[146:147], v18 offset:59904
    s_waitcnt lgkmcnt(6)
    v_mfma_f32_32x32x16_bf16 v[92:107], v[148:151], v[124:127], 0
    v_mfma_f32_32x32x16_bf16 v[108:123], v[148:151], v[128:131], 0
    ds_read_b64_tr_b16 v[148:149], v18 offset:43008
    ds_read_b64_tr_b16 v[150:151], v18 offset:43520
    s_waitcnt lgkmcnt(5)
    v_mfma_f32_32x32x16_bf16 v[28:43], v[140:143], v[132:135], v[28:43]
    ds_read_b128 v[124:127], v12 offset:40960
    s_waitcnt lgkmcnt(5)
    v_mfma_f32_32x32x16_bf16 v[44:59], v[140:143], v[136:139], v[44:59]
    ds_read_b64_tr_b16 v[140:141], v18 offset:53248
    ds_read_b64_tr_b16 v[142:143], v18 offset:53760
    s_waitcnt lgkmcnt(5)
    v_mfma_f32_32x32x16_bf16 v[60:75], v[132:135], v[144:147], v[60:75]
    ds_read_b128 v[128:131], v12 offset:45056
    v_mfma_f32_32x32x16_bf16 v[76:91], v[136:139], v[144:147], v[76:91]
    ds_read_b64_tr_b16 v[144:145], v18 offset:61440
    ds_read_b64_tr_b16 v[146:147], v18 offset:61952
    s_waitcnt lgkmcnt(6)
    v_mfma_f32_32x32x16_bf16 v[92:107], v[148:151], v[132:135], v[92:107]
    v_mfma_f32_32x32x16_bf16 v[108:123], v[148:151], v[136:139], v[108:123]
    ds_read_b64_tr_b16 v[148:149], v18 offset:45056
    ds_read_b64_tr_b16 v[150:151], v18 offset:45568
    s_waitcnt lgkmcnt(5)
    v_mfma_f32_32x32x16_bf16 v[28:43], v[140:143], v[124:127], v[28:43]
    ds_read_b128 v[132:135], v13 offset:40960
    s_waitcnt lgkmcnt(5)
    v_mfma_f32_32x32x16_bf16 v[44:59], v[140:143], v[128:131], v[44:59]
    ds_read_b64_tr_b16 v[140:141], v18 offset:55296
    ds_read_b64_tr_b16 v[142:143], v18 offset:55808
    s_waitcnt lgkmcnt(5)
    v_mfma_f32_32x32x16_bf16 v[60:75], v[124:127], v[144:147], v[60:75]
    ds_read_b128 v[136:139], v13 offset:45056
    v_mfma_f32_32x32x16_bf16 v[76:91], v[128:131], v[144:147], v[76:91]
    ds_read_b64_tr_b16 v[144:145], v18 offset:63488
    ds_read_b64_tr_b16 v[146:147], v18 offset:64000
    s_waitcnt lgkmcnt(6)
    v_mfma_f32_32x32x16_bf16 v[92:107], v[148:151], v[124:127], v[92:107]
    v_mfma_f32_32x32x16_bf16 v[108:123], v[148:151], v[128:131], v[108:123]
    ds_read_b64_tr_b16 v[148:149], v18 offset:47104
    ds_read_b64_tr_b16 v[150:151], v18 offset:47616
    s_waitcnt lgkmcnt(0)
    s_barrier
    v_mfma_f32_32x32x16_bf16 v[28:43], v[140:143], v[132:135], v[28:43]
    ds_read_b128 v[124:127], v14 offset:0
    v_mfma_f32_32x32x16_bf16 v[44:59], v[140:143], v[136:139], v[44:59]
    ds_read_b64_tr_b16 v[140:141], v19 offset:8192
    ds_read_b64_tr_b16 v[142:143], v19 offset:8704
    v_mfma_f32_32x32x16_bf16 v[60:75], v[132:135], v[144:147], v[60:75]
    ds_read_b128 v[128:131], v14 offset:4096
    v_mfma_f32_32x32x16_bf16 v[76:91], v[136:139], v[144:147], v[76:91]
    ds_read_b64_tr_b16 v[144:145], v19 offset:16384
    ds_read_b64_tr_b16 v[146:147], v19 offset:16896
    v_mfma_f32_32x32x16_bf16 v[92:107], v[148:151], v[132:135], v[92:107]
    v_mfma_f32_32x32x16_bf16 v[108:123], v[148:151], v[136:139], v[108:123]
    ds_read_b64_tr_b16 v[148:149], v19 offset:0
    ds_read_b64_tr_b16 v[150:151], v19 offset:512
    s_waitcnt lgkmcnt(5)
    v_mfma_f32_32x32x16_bf16 v[28:43], v[140:143], v[124:127], v[28:43]
    ds_read_b128 v[132:135], v15 offset:0
    s_waitcnt lgkmcnt(5)
    v_mfma_f32_32x32x16_bf16 v[44:59], v[140:143], v[128:131], v[44:59]
    ds_read_b64_tr_b16 v[140:141], v19 offset:10240
    ds_read_b64_tr_b16 v[142:143], v19 offset:10752
    s_waitcnt lgkmcnt(5)
    v_mfma_f32_32x32x16_bf16 v[60:75], v[124:127], v[144:147], v[60:75]
    ds_read_b128 v[136:139], v15 offset:4096
    v_mfma_f32_32x32x16_bf16 v[76:91], v[128:131], v[144:147], v[76:91]
    ds_read_b64_tr_b16 v[144:145], v19 offset:18432
    ds_read_b64_tr_b16 v[146:147], v19 offset:18944
    s_waitcnt lgkmcnt(6)
    v_mfma_f32_32x32x16_bf16 v[92:107], v[148:151], v[124:127], v[92:107]
    v_mfma_f32_32x32x16_bf16 v[108:123], v[148:151], v[128:131], v[108:123]
    ds_read_b64_tr_b16 v[148:149], v19 offset:2048
    ds_read_b64_tr_b16 v[150:151], v19 offset:2560
    s_waitcnt lgkmcnt(5)
    v_mfma_f32_32x32x16_bf16 v[28:43], v[140:143], v[132:135], v[28:43]
    ds_read_b128 v[124:127], v16 offset:0
    s_waitcnt lgkmcnt(5)
    v_mfma_f32_32x32x16_bf16 v[44:59], v[140:143], v[136:139], v[44:59]
    ds_read_b64_tr_b16 v[140:141], v19 offset:12288
    ds_read_b64_tr_b16 v[142:143], v19 offset:12800
    s_waitcnt lgkmcnt(5)
    v_mfma_f32_32x32x16_bf16 v[60:75], v[132:135], v[144:147], v[60:75]
    ds_read_b128 v[128:131], v16 offset:4096
    v_mfma_f32_32x32x16_bf16 v[76:91], v[136:139], v[144:147], v[76:91]
    ds_read_b64_tr_b16 v[144:145], v19 offset:20480
    ds_read_b64_tr_b16 v[146:147], v19 offset:20992
    s_waitcnt lgkmcnt(6)
    v_mfma_f32_32x32x16_bf16 v[92:107], v[148:151], v[132:135], v[92:107]
    v_mfma_f32_32x32x16_bf16 v[108:123], v[148:151], v[136:139], v[108:123]
    ds_read_b64_tr_b16 v[148:149], v19 offset:4096
    ds_read_b64_tr_b16 v[150:151], v19 offset:4608
    s_waitcnt lgkmcnt(5)
    v_mfma_f32_32x32x16_bf16 v[28:43], v[140:143], v[124:127], v[28:43]
    ds_read_b128 v[132:135], v17 offset:0
    s_waitcnt lgkmcnt(5)
    v_mfma_f32_32x32x16_bf16 v[44:59], v[140:143], v[128:131], v[44:59]
    ds_read_b64_tr_b16 v[140:141], v19 offset:14336
    ds_read_b64_tr_b16 v[142:143], v19 offset:14848
    s_waitcnt lgkmcnt(5)
    v_mfma_f32_32x32x16_bf16 v[60:75], v[124:127], v[144:147], v[60:75]
    ds_read_b128 v[136:139], v17 offset:4096
    v_mfma_f32_32x32x16_bf16 v[76:91], v[128:131], v[144:147], v[76:91]
    ds_read_b64_tr_b16 v[144:145], v19 offset:22528
    ds_read_b64_tr_b16 v[146:147], v19 offset:23040
    s_waitcnt lgkmcnt(6)
    v_mfma_f32_32x32x16_bf16 v[92:107], v[148:151], v[124:127], v[92:107]
    v_mfma_f32_32x32x16_bf16 v[108:123], v[148:151], v[128:131], v[108:123]
    ds_read_b64_tr_b16 v[148:149], v19 offset:6144
    ds_read_b64_tr_b16 v[150:151], v19 offset:6656
    s_waitcnt lgkmcnt(0)
    s_barrier
    v_mfma_f32_32x32x16_bf16 v[28:43], v[140:143], v[132:135], v[28:43]
    ds_read_b128 v[124:127], v10 offset:0
    v_mfma_f32_32x32x16_bf16 v[44:59], v[140:143], v[136:139], v[44:59]
    ds_read_b64_tr_b16 v[140:141], v18 offset:8192
    ds_read_b64_tr_b16 v[142:143], v18 offset:8704
    v_mfma_f32_32x32x16_bf16 v[60:75], v[132:135], v[144:147], v[60:75]
    ds_read_b128 v[128:131], v10 offset:4096
    v_mfma_f32_32x32x16_bf16 v[76:91], v[136:139], v[144:147], v[76:91]
    ds_read_b64_tr_b16 v[144:145], v18 offset:16384
    ds_read_b64_tr_b16 v[146:147], v18 offset:16896
    v_mfma_f32_32x32x16_bf16 v[92:107], v[148:151], v[132:135], v[92:107]
    v_mfma_f32_32x32x16_bf16 v[108:123], v[148:151], v[136:139], v[108:123]
    ds_read_b64_tr_b16 v[148:149], v18 offset:0
    ds_read_b64_tr_b16 v[150:151], v18 offset:512
    s_waitcnt lgkmcnt(5)
    v_mfma_f32_32x32x16_bf16 v[28:43], v[140:143], v[124:127], v[28:43]
    ds_read_b128 v[132:135], v11 offset:0
    s_waitcnt lgkmcnt(5)
    v_mfma_f32_32x32x16_bf16 v[44:59], v[140:143], v[128:131], v[44:59]
    ds_read_b64_tr_b16 v[140:141], v18 offset:10240
    ds_read_b64_tr_b16 v[142:143], v18 offset:10752
    s_waitcnt lgkmcnt(5)
    v_mfma_f32_32x32x16_bf16 v[60:75], v[124:127], v[144:147], v[60:75]
    ds_read_b128 v[136:139], v11 offset:4096
    v_mfma_f32_32x32x16_bf16 v[76:91], v[128:131], v[144:147], v[76:91]
    ds_read_b64_tr_b16 v[144:145], v18 offset:18432
    ds_read_b64_tr_b16 v[146:147], v18 offset:18944
    s_waitcnt lgkmcnt(6)
    v_mfma_f32_32x32x16_bf16 v[92:107], v[148:151], v[124:127], v[92:107]
    v_mfma_f32_32x32x16_bf16 v[108:123], v[148:151], v[128:131], v[108:123]
    ds_read_b64_tr_b16 v[148:149], v18 offset:2048
    ds_read_b64_tr_b16 v[150:151], v18 offset:2560
    s_mov_b32 s52, s14
    s_mov_b32 s53, s15
    s_mov_b32 s54, 524288
    s_mov_b32 s55, 0x00020000
    s_mov_b32 s36, s8
    s_mov_b32 s37, s9
    s_mov_b32 s38, 524288
    s_mov_b32 s39, 0x00020000
    s_and_b32 s62, s2, 1
    s_xor_b32 s62, s62, 0
    s_add_u32 s62, s62, s60
    s_cmp_lg_u32 s62, 0
    s_cbranch_scc1 L_npw_11
    s_lshl_b32 s62, s43, 14
    s_add_u32 s62, s62, 384
    v_lshlrev_b32 v23, 10, v0
    s_mov_b64 exec, 0xffff
    buffer_load_dword v22, v23, s[52:55], s62 offen
    buffer_load_dword v22, v23, s[36:39], s62 offen
    s_mov_b64 exec, -1
L_npw_11:
    s_waitcnt lgkmcnt(5)
    v_mfma_f32_32x32x16_bf16 v[28:43], v[140:143], v[132:135], v[28:43]
    ds_read_b128 v[124:127], v12 offset:0
    s_waitcnt lgkmcnt(5)
    v_mfma_f32_32x32x16_bf16 v[44:59], v[140:143], v[136:139], v[44:59]
    ds_read_b64_tr_b16 v[140:141], v18 offset:12288
    ds_read_b64_tr_b16 v[142:143], v18 offset:12800
    s_waitcnt lgkmcnt(5)
    v_mfma_f32_32x32x16_bf16 v[60:75], v[132:135], v[144:147], v[60:75]
    ds_read_b128 v[128:131], v12 offset:4096
    v_mfma_f32_32x32x16_bf16 v[76:91], v[136:139], v[144:147], v[76:91]
    ds_read_b64_tr_b16 v[144:145], v18 offset:20480
    ds_read_b64_tr_b16 v[146:147], v18 offset:20992
    s_waitcnt lgkmcnt(6)
    v_mfma_f32_32x32x16_bf16 v[92:107], v[148:151], v[132:135], v[92:107]
    v_mfma_f32_32x32x16_bf16 v[108:123], v[148:151], v[136:139], v[108:123]
    ds_read_b64_tr_b16 v[148:149], v18 offset:4096
    ds_read_b64_tr_b16 v[150:151], v18 offset:4608
    s_waitcnt lgkmcnt(5)
    v_mfma_f32_32x32x16_bf16 v[28:43], v[140:143], v[124:127], v[28:43]
    ds_read_b128 v[132:135], v13 offset:0
    s_waitcnt lgkmcnt(5)
    v_mfma_f32_32x32x16_bf16 v[44:59], v[140:143], v[128:131], v[44:59]
    ds_read_b64_tr_b16 v[140:141], v18 offset:14336
    ds_read_b64_tr_b16 v[142:143], v18 offset:14848
    s_waitcnt lgkmcnt(5)
    v_mfma_f32_32x32x16_bf16 v[60:75], v[124:127], v[144:147], v[60:75]
    ds_read_b128 v[136:139], v13 offset:4096
    v_mfma_f32_32x32x16_bf16 v[76:91], v[128:131], v[144:147], v[76:91]
    ds_read_b64_tr_b16 v[144:145], v18 offset:22528
    ds_read_b64_tr_b16 v[146:147], v18 offset:23040
    s_waitcnt lgkmcnt(6)
    v_mfma_f32_32x32x16_bf16 v[92:107], v[148:151], v[124:127], v[92:107]
    v_mfma_f32_32x32x16_bf16 v[108:123], v[148:151], v[128:131], v[108:123]
    ds_read_b64_tr_b16 v[148:149], v18 offset:6144
    ds_read_b64_tr_b16 v[150:151], v18 offset:6656
    s_waitcnt lgkmcnt(0)
    s_barrier
    v_mfma_f32_32x32x16_bf16 v[28:43], v[140:143], v[132:135], v[28:43]
    ds_read_b128 v[124:127], v10 offset:40960
    v_mfma_f32_32x32x16_bf16 v[44:59], v[140:143], v[136:139], v[44:59]
    ds_read_b64_tr_b16 v[140:141], v18 offset:49152
    ds_read_b64_tr_b16 v[142:143], v18 offset:49664
    v_mfma_f32_32x32x16_bf16 v[60:75], v[132:135], v[144:147], v[60:75]
    ds_read_b128 v[128:131], v10 offset:45056
    v_mfma_f32_32x32x16_bf16 v[76:91], v[136:139], v[144:147], v[76:91]
    ds_read_b64_tr_b16 v[144:145], v18 offset:57344
    ds_read_b64_tr_b16 v[146:147], v18 offset:57856
    v_mfma_f32_32x32x16_bf16 v[92:107], v[148:151], v[132:135], v[92:107]
    v_mfma_f32_32x32x16_bf16 v[108:123], v[148:151], v[136:139], v[108:123]
    ds_read_b64_tr_b16 v[148:149], v18 offset:40960
    ds_read_b64_tr_b16 v[150:151], v18 offset:41472
    s_waitcnt lgkmcnt(5)
    v_mfma_f32_32x32x16_bf16 v[28:43], v[140:143], v[124:127], v[28:43]
    ds_read_b128 v[132:135], v11 offset:40960
    s_waitcnt lgkmcnt(5)
    v_mfma_f32_32x32x16_bf16 v[44:59], v[140:143], v[128:131], v[44:59]
    ds_read_b64_tr_b16 v[140:141], v18 offset:51200
    ds_read_b64_tr_b16 v[142:143], v18 offset:51712
    s_waitcnt lgkmcnt(5)
    v_mfma_f32_32x32x16_bf16 v[60:75], v[124:127], v[144:147], v[60:75]
    ds_read_b128 v[136:139], v11 offset:45056
    v_mfma_f32_32x32x16_bf16 v[76:91], v[128:131], v[144:147], v[76:91]
    ds_read_b64_tr_b16 v[144:145], v18 offset:59392
    ds_read_b64_tr_b16 v[146:147], v18 offset:59904
    s_waitcnt lgkmcnt(6)
    v_mfma_f32_32x32x16_bf16 v[92:107], v[148:151], v[124:127], v[92:107]
    v_mfma_f32_32x32x16_bf16 v[108:123], v[148:151], v[128:131], v[108:123]
    ds_read_b64_tr_b16 v[148:149], v18 offset:43008
    ds_read_b64_tr_b16 v[150:151], v18 offset:43520
    s_waitcnt lgkmcnt(5)
    v_mfma_f32_32x32x16_bf16 v[28:43], v[140:143], v[132:135], v[28:43]
    ds_read_b128 v[124:127], v12 offset:40960
    s_waitcnt lgkmcnt(5)
    v_mfma_f32_32x32x16_bf16 v[44:59], v[140:143], v[136:139], v[44:59]
    ds_read_b64_tr_b16 v[140:141], v18 offset:53248
    ds_read_b64_tr_b16 v[142:143], v18 offset:53760
    s_waitcnt lgkmcnt(5)
    v_mfma_f32_32x32x16_bf16 v[60:75], v[132:135], v[144:147], v[60:75]
    ds_read_b128 v[128:131], v12 offset:45056
    v_mfma_f32_32x32x16_bf16 v[76:91], v[136:139], v[144:147], v[76:91]
    ds_read_b64_tr_b16 v[144:145], v18 offset:61440
    ds_read_b64_tr_b16 v[146:147], v18 offset:61952
    s_waitcnt lgkmcnt(6)
    v_mfma_f32_32x32x16_bf16 v[92:107], v[148:151], v[132:135], v[92:107]
    v_mfma_f32_32x32x16_bf16 v[108:123], v[148:151], v[136:139], v[108:123]
    ds_read_b64_tr_b16 v[148:149], v18 offset:45056
    ds_read_b64_tr_b16 v[150:151], v18 offset:45568
    s_waitcnt lgkmcnt(5)
    v_mfma_f32_32x32x16_bf16 v[28:43], v[140:143], v[124:127], v[28:43]
    ds_read_b128 v[132:135], v13 offset:40960
    s_waitcnt lgkmcnt(5)
    v_mfma_f32_32x32x16_bf16 v[44:59], v[140:143], v[128:131], v[44:59]
    ds_read_b64_tr_b16 v[140:141], v18 offset:55296
    ds_read_b64_tr_b16 v[142:143], v18 offset:55808
    s_waitcnt lgkmcnt(5)
    v_mfma_f32_32x32x16_bf16 v[60:75], v[124:127], v[144:147], v[60:75]
    ds_read_b128 v[136:139], v13 offset:45056
    v_mfma_f32_32x32x16_bf16 v[76:91], v[128:131], v[144:147], v[76:91]
    ds_read_b64_tr_b16 v[144:145], v18 offset:63488
    ds_read_b64_tr_b16 v[146:147], v18 offset:64000
    s_waitcnt lgkmcnt(6)
    v_mfma_f32_32x32x16_bf16 v[92:107], v[148:151], v[124:127], v[92:107]
    v_mfma_f32_32x32x16_bf16 v[108:123], v[148:151], v[128:131], v[108:123]
    ds_read_b64_tr_b16 v[148:149], v18 offset:47104
    ds_read_b64_tr_b16 v[150:151], v18 offset:47616
    s_waitcnt lgkmcnt(0)
    s_barrier
    v_mfma_f32_32x32x16_bf16 v[28:43], v[140:143], v[132:135], v[28:43]
    ds_read_b128 v[124:127], v14 offset:0
    v_mfma_f32_32x32x16_bf16 v[44:59], v[140:143], v[136:139], v[44:59]
    ds_read_b64_tr_b16 v[140:141], v19 offset:8192
    ds_read_b64_tr_b16 v[142:143], v19 offset:8704
    v_mfma_f32_32x32x16_bf16 v[60:75], v[132:135], v[144:147], v[60:75]
    ds_read_b128 v[128:131], v14 offset:4096
    v_mfma_f32_32x32x16_bf16 v[76:91], v[136:139], v[144:147], v[76:91]
    ds_read_b64_tr_b16 v[144:145], v19 offset:16384
    ds_read_b64_tr_b16 v[146:147], v19 offset:16896
    v_mfma_f32_32x32x16_bf16 v[92:107], v[148:151], v[132:135], v[92:107]
    v_mfma_f32_32x32x16_bf16 v[108:123], v[148:151], v[136:139], v[108:123]
    ds_read_b64_tr_b16 v[148:149], v19 offset:0
    ds_read_b64_tr_b16 v[150:151], v19 offset:512
    s_waitcnt lgkmcnt(5)
    v_mfma_f32_32x32x16_bf16 v[28:43], v[140:143], v[124:127], v[28:43]
    ds_read_b128 v[132:135], v15 offset:0
    s_waitcnt lgkmcnt(5)
    v_mfma_f32_32x32x16_bf16 v[44:59], v[140:143], v[128:131], v[44:59]
    ds_read_b64_tr_b16 v[140:141], v19 offset:10240
    ds_read_b64_tr_b16 v[142:143], v19 offset:10752
    s_waitcnt lgkmcnt(5)
    v_mfma_f32_32x32x16_bf16 v[60:75], v[124:127], v[144:147], v[60:75]
    ds_read_b128 v[136:139], v15 offset:4096
    v_mfma_f32_32x32x16_bf16 v[76:91], v[128:131], v[144:147], v[76:91]
    ds_read_b64_tr_b16 v[144:145], v19 offset:18432
    ds_read_b64_tr_b16 v[146:147], v19 offset:18944
    s_waitcnt lgkmcnt(6)
    v_mfma_f32_32x32x16_bf16 v[92:107], v[148:151], v[124:127], v[92:107]
    v_mfma_f32_32x32x16_bf16 v[108:123], v[148:151], v[128:131], v[108:123]
    ds_read_b64_tr_b16 v[148:149], v19 offset:2048
    ds_read_b64_tr_b16 v[150:151], v19 offset:2560
    s_waitcnt lgkmcnt(5)
    v_mfma_f32_32x32x16_bf16 v[28:43], v[140:143], v[132:135], v[28:43]
    ds_read_b128 v[124:127], v16 offset:0
    s_waitcnt lgkmcnt(5)
    v_mfma_f32_32x32x16_bf16 v[44:59], v[140:143], v[136:139], v[44:59]
    ds_read_b64_tr_b16 v[140:141], v19 offset:12288
    ds_read_b64_tr_b16 v[142:143], v19 offset:12800
    s_waitcnt lgkmcnt(5)
    v_mfma_f32_32x32x16_bf16 v[60:75], v[132:135], v[144:147], v[60:75]
    ds_read_b128 v[128:131], v16 offset:4096
    v_mfma_f32_32x32x16_bf16 v[76:91], v[136:139], v[144:147], v[76:91]
    ds_read_b64_tr_b16 v[144:145], v19 offset:20480
    ds_read_b64_tr_b16 v[146:147], v19 offset:20992
    s_waitcnt lgkmcnt(6)
    v_mfma_f32_32x32x16_bf16 v[92:107], v[148:151], v[132:135], v[92:107]
    v_mfma_f32_32x32x16_bf16 v[108:123], v[148:151], v[136:139], v[108:123]
    ds_read_b64_tr_b16 v[148:149], v19 offset:4096
    ds_read_b64_tr_b16 v[150:151], v19 offset:4608
    s_waitcnt lgkmcnt(5)
    v_mfma_f32_32x32x16_bf16 v[28:43], v[140:143], v[124:127], v[28:43]
    ds_read_b128 v[132:135], v17 offset:0
    s_waitcnt lgkmcnt(5)
    v_mfma_f32_32x32x16_bf16 v[44:59], v[140:143], v[128:131], v[44:59]
    ds_read_b64_tr_b16 v[140:141], v19 offset:14336
    ds_read_b64_tr_b16 v[142:143], v19 offset:14848
    s_waitcnt lgkmcnt(5)
    v_mfma_f32_32x32x16_bf16 v[60:75], v[124:127], v[144:147], v[60:75]
    ds_read_b128 v[136:139], v17 offset:4096
    v_mfma_f32_32x32x16_bf16 v[76:91], v[128:131], v[144:147], v[76:91]
    ds_read_b64_tr_b16 v[144:145], v19 offset:22528
    ds_read_b64_tr_b16 v[146:147], v19 offset:23040
    s_waitcnt lgkmcnt(6)
    v_mfma_f32_32x32x16_bf16 v[92:107], v[148:151], v[124:127], v[92:107]
    v_mfma_f32_32x32x16_bf16 v[108:123], v[148:151], v[128:131], v[108:123]
    ds_read_b64_tr_b16 v[148:149], v19 offset:6144
    ds_read_b64_tr_b16 v[150:151], v19 offset:6656
    s_waitcnt lgkmcnt(0)
    s_barrier
    v_mfma_f32_32x32x16_bf16 v[28:43], v[140:143], v[132:135], v[28:43]
    ds_read_b128 v[124:127], v10 offset:0
    v_mfma_f32_32x32x16_bf16 v[44:59], v[140:143], v[136:139], v[44:59]
    ds_read_b64_tr_b16 v[140:141], v18 offset:8192
    ds_read_b64_tr_b16 v[142:143], v18 offset:8704
    v_mfma_f32_32x32x16_bf16 v[60:75], v[132:135], v[144:147], v[60:75]
    ds_read_b128 v[128:131], v10 offset:4096
    v_mfma_f32_32x32x16_bf16 v[76:91], v[136:139], v[144:147], v[76:91]
    ds_read_b64_tr_b16 v[144:145], v18 offset:16384
    ds_read_b64_tr_b16 v[146:147], v18 offset:16896
    v_mfma_f32_32x32x16_bf16 v[92:107], v[148:151], v[132:135], v[92:107]
    v_mfma_f32_32x32x16_bf16 v[108:123], v[148:151], v[136:139], v[108:123]
    ds_read_b64_tr_b16 v[148:149], v18 offset:0
    ds_read_b64_tr_b16 v[150:151], v18 offset:512
    s_waitcnt lgkmcnt(5)
    v_mfma_f32_32x32x16_bf16 v[28:43], v[140:143], v[124:127], v[28:43]
    ds_read_b128 v[132:135], v11 offset:0
    s_waitcnt lgkmcnt(5)
    v_mfma_f32_32x32x16_bf16 v[44:59], v[140:143], v[128:131], v[44:59]
    ds_read_b64_tr_b16 v[140:141], v18 offset:10240
    ds_read_b64_tr_b16 v[142:143], v18 offset:10752
    s_waitcnt lgkmcnt(5)
    v_mfma_f32_32x32x16_bf16 v[60:75], v[124:127], v[144:147], v[60:75]
    ds_read_b128 v[136:139], v11 offset:4096
    v_mfma_f32_32x32x16_bf16 v[76:91], v[128:131], v[144:147], v[76:91]
    ds_read_b64_tr_b16 v[144:145], v18 offset:18432
    ds_read_b64_tr_b16 v[146:147], v18 offset:18944
    s_waitcnt lgkmcnt(6)
    v_mfma_f32_32x32x16_bf16 v[92:107], v[148:151], v[124:127], v[92:107]
    v_mfma_f32_32x32x16_bf16 v[108:123], v[148:151], v[128:131], v[108:123]
    ds_read_b64_tr_b16 v[148:149], v18 offset:2048
    ds_read_b64_tr_b16 v[150:151], v18 offset:2560
    s_waitcnt lgkmcnt(5)
    v_mfma_f32_32x32x16_bf16 v[28:43], v[140:143], v[132:135], v[28:43]
    ds_read_b128 v[124:127], v12 offset:0
    s_waitcnt lgkmcnt(5)
    v_mfma_f32_32x32x16_bf16 v[44:59], v[140:143], v[136:139], v[44:59]
    ds_read_b64_tr_b16 v[140:141], v18 offset:12288
    ds_read_b64_tr_b16 v[142:143], v18 offset:12800
    s_waitcnt lgkmcnt(5)
    v_mfma_f32_32x32x16_bf16 v[60:75], v[132:135], v[144:147], v[60:75]
    ds_read_b128 v[128:131], v12 offset:4096
    v_mfma_f32_32x32x16_bf16 v[76:91], v[136:139], v[144:147], v[76:91]
    ds_read_b64_tr_b16 v[144:145], v18 offset:20480
    ds_read_b64_tr_b16 v[146:147], v18 offset:20992
    s_waitcnt lgkmcnt(6)
    v_mfma_f32_32x32x16_bf16 v[92:107], v[148:151], v[132:135], v[92:107]
    v_mfma_f32_32x32x16_bf16 v[108:123], v[148:151], v[136:139], v[108:123]
    ds_read_b64_tr_b16 v[148:149], v18 offset:4096
    ds_read_b64_tr_b16 v[150:151], v18 offset:4608
    s_waitcnt lgkmcnt(5)
    v_mfma_f32_32x32x16_bf16 v[28:43], v[140:143], v[124:127], v[28:43]
    ds_read_b128 v[132:135], v13 offset:0
    s_waitcnt lgkmcnt(5)
    v_mfma_f32_32x32x16_bf16 v[44:59], v[140:143], v[128:131], v[44:59]
    ds_read_b64_tr_b16 v[140:141], v18 offset:14336
    ds_read_b64_tr_b16 v[142:143], v18 offset:14848
    s_waitcnt lgkmcnt(5)
    v_mfma_f32_32x32x16_bf16 v[60:75], v[124:127], v[144:147], v[60:75]
    ds_read_b128 v[136:139], v13 offset:4096
    v_mfma_f32_32x32x16_bf16 v[76:91], v[128:131], v[144:147], v[76:91]
    ds_read_b64_tr_b16 v[144:145], v18 offset:22528
    ds_read_b64_tr_b16 v[146:147], v18 offset:23040
    s_waitcnt lgkmcnt(6)
    v_mfma_f32_32x32x16_bf16 v[92:107], v[148:151], v[124:127], v[92:107]
    v_mfma_f32_32x32x16_bf16 v[108:123], v[148:151], v[128:131], v[108:123]
    buffer_load_dwordx2 v[6:7], v5, s[48:51], 0 offen sc1
    s_waitcnt lgkmcnt(0)
    s_barrier
    v_mfma_f32_32x32x16_bf16 v[28:43], v[140:143], v[132:135], v[28:43]
    ds_read_b128 v[124:127], v10 offset:40960
    v_mfma_f32_32x32x16_bf16 v[44:59], v[140:143], v[136:139], v[44:59]
    ds_read_b64_tr_b16 v[140:141], v18 offset:49152
    ds_read_b64_tr_b16 v[142:143], v18 offset:49664
    v_mfma_f32_32x32x16_bf16 v[60:75], v[132:135], v[144:147], v[60:75]
    ds_read_b128 v[128:131], v10 offset:45056
    v_mfma_f32_32x32x16_bf16 v[76:91], v[136:139], v[144:147], v[76:91]
    ds_read_b64_tr_b16 v[144:145], v18 offset:57344
    ds_read_b64_tr_b16 v[146:147], v18 offset:57856
    s_waitcnt lgkmcnt(3)
    v_mfma_f32_32x32x16_bf16 v[28:43], v[140:143], v[124:127], v[28:43]
    ds_read_b128 v[132:135], v11 offset:40960
    s_waitcnt lgkmcnt(3)
    v_mfma_f32_32x32x16_bf16 v[44:59], v[140:143], v[128:131], v[44:59]
    ds_read_b64_tr_b16 v[140:141], v18 offset:51200
    ds_read_b64_tr_b16 v[142:143], v18 offset:51712
    s_waitcnt lgkmcnt(3)
    v_mfma_f32_32x32x16_bf16 v[60:75], v[124:127], v[144:147], v[60:75]
    ds_read_b128 v[136:139], v11 offset:45056
    v_mfma_f32_32x32x16_bf16 v[76:91], v[128:131], v[144:147], v[76:91]
    ds_read_b64_tr_b16 v[144:145], v18 offset:59392
    ds_read_b64_tr_b16 v[146:147], v18 offset:59904
    s_waitcnt lgkmcnt(3)
    v_mfma_f32_32x32x16_bf16 v[28:43], v[140:143], v[132:135], v[28:43]
    ds_read_b128 v[124:127], v12 offset:40960
    s_waitcnt lgkmcnt(3)
    v_mfma_f32_32x32x16_bf16 v[44:59], v[140:143], v[136:139], v[44:59]
    ds_read_b64_tr_b16 v[140:141], v18 offset:53248
    ds_read_b64_tr_b16 v[142:143], v18 offset:53760
    s_waitcnt lgkmcnt(3)
    v_mfma_f32_32x32x16_bf16 v[60:75], v[132:135], v[144:147], v[60:75]
    ds_read_b128 v[128:131], v12 offset:45056
    v_mfma_f32_32x32x16_bf16 v[76:91], v[136:139], v[144:147], v[76:91]
    ds_read_b64_tr_b16 v[144:145], v18 offset:61440
    ds_read_b64_tr_b16 v[146:147], v18 offset:61952
    s_waitcnt lgkmcnt(3)
    v_mfma_f32_32x32x16_bf16 v[28:43], v[140:143], v[124:127], v[28:43]
    ds_read_b128 v[132:135], v13 offset:40960
    s_waitcnt lgkmcnt(3)
    v_mfma_f32_32x32x16_bf16 v[44:59], v[140:143], v[128:131], v[44:59]
    ds_read_b64_tr_b16 v[140:141], v18 offset:55296
    ds_read_b64_tr_b16 v[142:143], v18 offset:55808
    s_waitcnt lgkmcnt(3)
    v_mfma_f32_32x32x16_bf16 v[60:75], v[124:127], v[144:147], v[60:75]
    ds_read_b128 v[136:139], v13 offset:45056
    v_mfma_f32_32x32x16_bf16 v[76:91], v[128:131], v[144:147], v[76:91]
    ds_read_b64_tr_b16 v[144:145], v18 offset:63488
    ds_read_b64_tr_b16 v[146:147], v18 offset:64000
    s_waitcnt lgkmcnt(0)
    s_barrier
    v_mfma_f32_32x32x16_bf16 v[28:43], v[140:143], v[132:135], v[28:43]
    ds_read_b128 v[124:127], v14 offset:0
    v_mfma_f32_32x32x16_bf16 v[44:59], v[140:143], v[136:139], v[44:59]
    ds_read_b64_tr_b16 v[140:141], v19 offset:8192
    ds_read_b64_tr_b16 v[142:143], v19 offset:8704
    v_mfma_f32_32x32x16_bf16 v[60:75], v[132:135], v[144:147], v[60:75]
    ds_read_b128 v[128:131], v14 offset:4096
    v_mfma_f32_32x32x16_bf16 v[76:91], v[136:139], v[144:147], v[76:91]
    ds_read_b64_tr_b16 v[144:145], v19 offset:16384
    ds_read_b64_tr_b16 v[146:147], v19 offset:16896
    s_waitcnt lgkmcnt(3)
    v_mfma_f32_32x32x16_bf16 v[28:43], v[140:143], v[124:127], v[28:43]
    ds_read_b128 v[132:135], v15 offset:0
    s_waitcnt lgkmcnt(3)
    v_mfma_f32_32x32x16_bf16 v[44:59], v[140:143], v[128:131], v[44:59]
    ds_read_b64_tr_b16 v[140:141], v19 offset:10240
    ds_read_b64_tr_b16 v[142:143], v19 offset:10752
    s_waitcnt lgkmcnt(3)
    v_mfma_f32_32x32x16_bf16 v[60:75], v[124:127], v[144:147], v[60:75]
    ds_read_b128 v[136:139], v15 offset:4096
    v_mfma_f32_32x32x16_bf16 v[76:91], v[128:131], v[144:147], v[76:91]
    ds_read_b64_tr_b16 v[144:145], v19 offset:18432
    ds_read_b64_tr_b16 v[146:147], v19 offset:18944
    s_waitcnt lgkmcnt(3)
    v_mfma_f32_32x32x16_bf16 v[28:43], v[140:143], v[132:135], v[28:43]
    ds_read_b128 v[124:127], v16 offset:0
    s_waitcnt lgkmcnt(3)
    v_mfma_f32_32x32x16_bf16 v[44:59], v[140:143], v[136:139], v[44:59]
    ds_read_b64_tr_b16 v[140:141], v19 offset:12288
    ds_read_b64_tr_b16 v[142:143], v19 offset:12800
    s_waitcnt lgkmcnt(3)
    v_mfma_f32_32x32x16_bf16 v[60:75], v[132:135], v[144:147], v[60:75]
    ds_read_b128 v[128:131], v16 offset:4096
    v_mfma_f32_32x32x16_bf16 v[76:91], v[136:139], v[144:147], v[76:91]
    ds_read_b64_tr_b16 v[144:145], v19 offset:20480
    ds_read_b64_tr_b16 v[146:147], v19 offset:20992
    s_waitcnt lgkmcnt(3)
    v_mfma_f32_32x32x16_bf16 v[28:43], v[140:143], v[124:127], v[28:43]
    ds_read_b128 v[132:135], v17 offset:0
    s_waitcnt lgkmcnt(3)
    v_mfma_f32_32x32x16_bf16 v[44:59], v[140:143], v[128:131], v[44:59]
    ds_read_b64_tr_b16 v[140:141], v19 offset:14336
    ds_read_b64_tr_b16 v[142:143], v19 offset:14848
    s_waitcnt lgkmcnt(3)
    v_mfma_f32_32x32x16_bf16 v[60:75], v[124:127], v[144:147], v[60:75]
    ds_read_b128 v[136:139], v17 offset:4096
    v_mfma_f32_32x32x16_bf16 v[76:91], v[128:131], v[144:147], v[76:91]
    ds_read_b64_tr_b16 v[144:145], v19 offset:22528
    ds_read_b64_tr_b16 v[146:147], v19 offset:23040
    ds_read_b128 v[156:159], v13 offset:0
    ds_read_b128 v[160:163], v13 offset:4096
    ds_read_b64_tr_b16 v[148:149], v18 offset:6144
    ds_read_b64_tr_b16 v[150:151], v18 offset:6656
    s_waitcnt lgkmcnt(7)
    v_mfma_f32_32x32x16_bf16 v[28:43], v[140:143], v[132:135], v[28:43]
    s_waitcnt lgkmcnt(6)
    v_mfma_f32_32x32x16_bf16 v[44:59], v[140:143], v[136:139], v[44:59]
    s_waitcnt lgkmcnt(4)
    v_mfma_f32_32x32x16_bf16 v[60:75], v[132:135], v[144:147], v[60:75]
    v_mfma_f32_32x32x16_bf16 v[76:91], v[136:139], v[144:147], v[76:91]
    s_cmp_lg_u32 s26, 0
    s_cbranch_scc1 L_epa
    s_lshl_b32 s62, s78, 11
    s_lshl_b32 s63, s83, 18
    s_add_u32 s62, s62, s63
    s_lshl_b32 s63, s40, 19
    s_add_u32 s73, s62, s63
    s_add_u32 s79, s73, 131072
    s_lshl_b32 s63, s41, 19
    s_add_u32 s74, s62, s63
    s_lshr_b32 s75, s62, 1
    s_lshl_b32 s63, s3, 18
    s_add_u32 s75, s75, s63
    s_add_u32 s75, s75, 10485760
    s_add_u32 s80, s75, 65536
    v_lshl_add_u32 v2, v21, 17, v9
    ds_read_b128 v[124:127], v10 offset:40960
    ds_read_b128 v[128:131], v10 offset:45056
    ds_read_b64_tr_b16 v[152:153], v18 offset:40960
    ds_read_b64_tr_b16 v[154:155], v18 offset:41472
    s_waitcnt lgkmcnt(4)
    v_mfma_f32_32x32x16_bf16 v[92:107], v[148:151], v[156:159], v[92:107]
    ds_read_b128 v[132:135], v11 offset:40960
    ds_read_b128 v[136:139], v11 offset:45056
    ds_read_b64_tr_b16 v[140:141], v18 offset:43008
    ds_read_b64_tr_b16 v[142:143], v18 offset:43520
    v_cvt_pk_bf16_f32 v28, v28, v29
    v_cvt_pk_bf16_f32 v29, v30, v31
    v_cvt_pk_bf16_f32 v30, v32, v33
    v_cvt_pk_bf16_f32 v31, v34, v35
    v_mfma_f32_32x32x16_bf16 v[108:123], v[148:151], v[160:163], v[108:123]
    v_cvt_pk_bf16_f32 v32, v36, v37
    v_cvt_pk_bf16_f32 v33, v38, v39
    v_cvt_pk_bf16_f32 v34, v40, v41
    v_cvt_pk_bf16_f32 v35, v42, v43
    s_waitcnt lgkmcnt(4)
    v_mfma_f32_32x32x16_bf16 v[92:107], v[152:155], v[124:127], v[92:107]
    ds_read_b128 v[156:159], v12 offset:40960
    ds_read_b128 v[160:163], v12 offset:45056
    ds_read_b64_tr_b16 v[148:149], v18 offset:45056
    ds_read_b64_tr_b16 v[150:151], v18 offset:45568
    buffer_store_dwordx4 v[28:31], v8, s[44:47], s73 offen offset:0 sc1
    buffer_store_dwordx4 v[32:35], v8, s[44:47], s79 offen offset:0 sc1
    v_cvt_pk_bf16_f32 v44, v44, v45
    v_cvt_pk_bf16_f32 v45, v46, v47
    v_mfma_f32_32x32x16_bf16 v[108:123], v[152:155], v[128:131], v[108:123]
    v_cvt_pk_bf16_f32 v46, v48, v49
    v_cvt_pk_bf16_f32 v47, v50, v51
    v_cvt_pk_bf16_f32 v48, v52, v53
    v_cvt_pk_bf16_f32 v49, v54, v55
    s_waitcnt lgkmcnt(4)
    v_mfma_f32_32x32x16_bf16 v[92:107], v[140:143], v[132:135], v[92:107]
    ds_read_b128 v[124:127], v13 offset:40960
    ds_read_b128 v[128:131], v13 offset:45056
    ds_read_b64_tr_b16 v[152:153], v18 offset:47104
    ds_read_b64_tr_b16 v[154:155], v18 offset:47616
    v_cvt_pk_bf16_f32 v50, v56, v57
    v_cvt_pk_bf16_f32 v51, v58, v59
    buffer_store_dwordx4 v[44:47], v8, s[44:47], s73 offen offset:2048 sc1
    buffer_store_dwordx4 v[48:51], v8, s[44:47], s79 offen offset:2048 sc1
    v_mfma_f32_32x32x16_bf16 v[108:123], v[140:143], v[136:139], v[108:123]
    v_cvt_pk_bf16_f32 v60, v60, v61
    v_cvt_pk_bf16_f32 v61, v62, v63
    v_cvt_pk_bf16_f32 v62, v64, v65
    v_cvt_pk_bf16_f32 v63, v66, v67
    s_waitcnt lgkmcnt(4)
    v_mfma_f32_32x32x16_bf16 v[92:107], v[148:151], v[156:159], v[92:107]
    ds_read_b128 v[132:135], v14 offset:0
    ds_read_b128 v[136:139], v14 offset:4096
    ds_read_b64_tr_b16 v[140:141], v19 offset:0
    ds_read_b64_tr_b16 v[142:143], v19 offset:512
    v_cvt_pk_bf16_f32 v64, v68, v69
    v_cvt_pk_bf16_f32 v65, v70, v71
    v_cvt_pk_bf16_f32 v66, v72, v73
    v_cvt_pk_bf16_f32 v67, v74, v75
    v_mfma_f32_32x32x16_bf16 v[108:123], v[148:151], v[160:163], v[108:123]
    buffer_store_dwordx4 v[60:63], v2, s[44:47], s74 offen offset:1024 sc1
    buffer_store_dwordx4 v[64:67], v2, s[44:47], s74 offen offset:1536 sc1
    v_cvt_pk_bf16_f32 v76, v76, v77
    v_cvt_pk_bf16_f32 v77, v78, v79
    s_waitcnt lgkmcnt(4)
    v_mfma_f32_32x32x16_bf16 v[92:107], v[152:155], v[124:127], v[92:107]
    ds_read_b128 v[156:159], v15 offset:0
    ds_read_b128 v[160:163], v15 offset:4096
    ds_read_b64_tr_b16 v[148:149], v19 offset:2048
    ds_read_b64_tr_b16 v[150:151], v19 offset:2560
    v_cvt_pk_bf16_f32 v78, v80, v81
    v_cvt_pk_bf16_f32 v79, v82, v83
    v_cvt_pk_bf16_f32 v80, v84, v85
    v_cvt_pk_bf16_f32 v81, v86, v87
    v_mfma_f32_32x32x16_bf16 v[108:123], v[152:155], v[128:131], v[108:123]
    v_cvt_pk_bf16_f32 v82, v88, v89
    v_cvt_pk_bf16_f32 v83, v90, v91
    buffer_store_dwordx4 v[76:79], v2, s[44:47], s74 offen offset:3072 sc1
    buffer_store_dwordx4 v[80:83], v2, s[44:47], s74 offen offset:3584 sc1
    s_waitcnt lgkmcnt(4)
    v_mfma_f32_32x32x16_bf16 v[92:107], v[140:143], v[132:135], v[92:107]
    ds_read_b128 v[124:127], v16 offset:0
    ds_read_b128 v[128:131], v16 offset:4096
    ds_read_b64_tr_b16 v[152:153], v19 offset:4096
    ds_read_b64_tr_b16 v[154:155], v19 offset:4608
    v_mfma_f32_32x32x16_bf16 v[108:123], v[140:143], v[136:139], v[108:123]
    s_waitcnt lgkmcnt(4)
    v_mfma_f32_32x32x16_bf16 v[92:107], v[148:151], v[156:159], v[92:107]
    ds_read_b128 v[132:135], v17 offset:0
    ds_read_b128 v[136:139], v17 offset:4096
    ds_read_b64_tr_b16 v[140:141], v19 offset:6144
    ds_read_b64_tr_b16 v[142:143], v19 offset:6656
    v_mfma_f32_32x32x16_bf16 v[108:123], v[148:151], v[160:163], v[108:123]
    s_waitcnt lgkmcnt(4)
    v_mfma_f32_32x32x16_bf16 v[92:107], v[152:155], v[124:127], v[92:107]
    v_mfma_f32_32x32x16_bf16 v[108:123], v[152:155], v[128:131], v[108:123]
    s_waitcnt lgkmcnt(0)
    v_mfma_f32_32x32x16_bf16 v[92:107], v[140:143], v[132:135], v[92:107]
    v_mfma_f32_32x32x16_bf16 v[108:123], v[140:143], v[136:139], v[108:123]
    s_waitcnt lgkmcnt(0)
    s_barrier
    s_nop 9
    v_pk_mul_f32 v[92:93], v[92:93], s[84:85]
    v_pk_mul_f32 v[94:95], v[94:95], s[84:85]
    v_pk_mul_f32 v[96:97], v[96:97], s[84:85]
    v_pk_mul_f32 v[98:99], v[98:99], s[84:85]
    v_pk_mul_f32 v[100:101], v[100:101], s[84:85]
    v_pk_mul_f32 v[102:103], v[102:103], s[84:85]
    v_pk_mul_f32 v[104:105], v[104:105], s[84:85]
    v_pk_mul_f32 v[106:107], v[106:107], s[84:85]
    v_cvt_pk_bf16_f32 v92, v92, v93
    v_cvt_pk_bf16_f32 v93, v94, v95
    v_cvt_pk_bf16_f32 v94, v96, v97
    v_cvt_pk_bf16_f32 v95, v98, v99
    v_cvt_pk_bf16_f32 v96, v100, v101
    v_cvt_pk_bf16_f32 v97, v102, v103
    v_cvt_pk_bf16_f32 v98, v104, v105
    v_cvt_pk_bf16_f32 v99, v106, v107
    buffer_store_dwordx4 v[92:95], v8, s[44:47], s75 offen offset:0 sc1
    buffer_store_dwordx4 v[96:99], v8, s[44:47], s80 offen offset:0 sc1
    v_pk_mul_f32 v[108:109], v[108:109], s[84:85]
    v_pk_mul_f32 v[110:111], v[110:111], s[84:85]
    v_pk_mul_f32 v[112:113], v[112:113], s[84:85]
    v_pk_mul_f32 v[114:115], v[114:115], s[84:85]
    v_pk_mul_f32 v[116:117], v[116:117], s[84:85]
    v_pk_mul_f32 v[118:119], v[118:119], s[84:85]
    v_pk_mul_f32 v[120:121], v[120:121], s[84:85]
    v_pk_mul_f32 v[122:123], v[122:123], s[84:85]
    v_cvt_pk_bf16_f32 v108, v108, v109
    v_cvt_pk_bf16_f32 v109, v110, v111
    v_cvt_pk_bf16_f32 v110, v112, v113
    v_cvt_pk_bf16_f32 v111, v114, v115
    v_cvt_pk_bf16_f32 v112, v116, v117
    v_cvt_pk_bf16_f32 v113, v118, v119
    v_cvt_pk_bf16_f32 v114, v120, v121
    v_cvt_pk_bf16_f32 v115, v122, v123
    buffer_store_dwordx4 v[108:111], v8, s[44:47], s75 offen offset:1024 sc1
    buffer_store_dwordx4 v[112:115], v8, s[44:47], s80 offen offset:1024 sc1
    s_waitcnt vmcnt(12)
    s_mov_b32 s66, 0
L_non_12:
    v_readfirstlane_b32 s64, v6
    v_readfirstlane_b32 s65, v7
    s_add_u32 s66, s66, 1
    s_cmp_gt_u32 s66, 30000
    s_cbranch_scc1 L_nond_13
    s_cmp_eq_u32 s64, 0
    s_cselect_b32 s63, 0, s65
    s_cmp_lg_u32 s63, 0
    s_cbranch_scc1 L_nond_13
    buffer_load_dwordx2 v[6:7], v5, s[48:51], 0 offen sc1
    s_waitcnt vmcnt(0)
    s_branch L_non_12
L_nond_13:
    s_lshl_b32 s77, s77, 7
    s_add_u32 s77, s77, 8388608
    s_waitcnt vmcnt(0)
    s_barrier
    s_cmp_lg_u32 s60, 0
    s_cbranch_scc1 L_wo
    s_mov_b64 exec, 1
    buffer_store_dwordx2 v[6:7], v5, s[44:47], s77 offen sc1
    s_mov_b64 exec, -1
    s_branch L_wo
L_epa:
    s_lshl_b32 s62, s82, 14
    s_lshl_b32 s63, s83, 12
    s_add_u32 s71, s62, s63
    s_add_u32 s62, s71, 81920
    v_add_u32 v3, s62, v20
    v_lshl_add_u32 v2, v21, 11, v9
    v_add_u32 v4, s62, v2
    s_lshl_b32 s76, s77, 13
    s_add_u32 s76, s76, 12582912
    s_add_u32 s63, s63, s76
    s_lshl_b32 s77, s77, 1
    s_add_u32 s77, s77, s83
    s_lshl_b32 s77, s77, 7
    s_add_u32 s77, s77, 8552448
    ds_read_b128 v[124:127], v10 offset:40960
    ds_read_b128 v[128:131], v10 offset:45056
    ds_read_b64_tr_b16 v[152:153], v18 offset:40960
    ds_read_b64_tr_b16 v[154:155], v18 offset:41472
    s_waitcnt lgkmcnt(4)
    v_mfma_f32_32x32x16_bf16 v[92:107], v[148:151], v[156:159], v[92:107]
    ds_read_b128 v[132:135], v11 offset:40960
    ds_read_b128 v[136:139], v11 offset:45056
    ds_read_b64_tr_b16 v[140:141], v18 offset:43008
    ds_read_b64_tr_b16 v[142:143], v18 offset:43520
    v_cvt_pk_bf16_f32 v44, v44, v45
    v_cvt_pk_bf16_f32 v45, v46, v47
    v_cvt_pk_bf16_f32 v46, v48, v49
    v_cvt_pk_bf16_f32 v47, v50, v51
    v_mfma_f32_32x32x16_bf16 v[108:123], v[148:151], v[160:163], v[108:123]
    v_cvt_pk_bf16_f32 v48, v52, v53
    v_cvt_pk_bf16_f32 v49, v54, v55
    v_cvt_pk_bf16_f32 v50, v56, v57
    v_cvt_pk_bf16_f32 v51, v58, v59
    s_waitcnt lgkmcnt(4)
    v_mfma_f32_32x32x16_bf16 v[92:107], v[152:155], v[124:127], v[92:107]
    ds_read_b128 v[156:159], v12 offset:40960
    ds_read_b128 v[160:163], v12 offset:45056
    ds_read_b64_tr_b16 v[148:149], v18 offset:45056
    ds_read_b64_tr_b16 v[150:151], v18 offset:45568
    v_cvt_pk_bf16_f32 v76, v76, v77
    v_cvt_pk_bf16_f32 v77, v78, v79
    v_cvt_pk_bf16_f32 v78, v80, v81
    v_cvt_pk_bf16_f32 v79, v82, v83
    v_mfma_f32_32x32x16_bf16 v[108:123], v[152:155], v[128:131], v[108:123]
    v_cvt_pk_bf16_f32 v80, v84, v85
    v_cvt_pk_bf16_f32 v81, v86, v87
    v_cvt_pk_bf16_f32 v82, v88, v89
    v_cvt_pk_bf16_f32 v83, v90, v91
    s_waitcnt lgkmcnt(4)
    v_mfma_f32_32x32x16_bf16 v[92:107], v[140:143], v[132:135], v[92:107]
    ds_read_b128 v[124:127], v13 offset:40960
    ds_read_b128 v[128:131], v13 offset:45056
    ds_read_b64_tr_b16 v[152:153], v18 offset:47104
    ds_read_b64_tr_b16 v[154:155], v18 offset:47616
    s_cmp_lg_u32 s82, 1
    s_cbranch_scc1 L_noha
    buffer_store_dwordx4 v[44:47], v20, s[44:47], s63 offen sc1
    buffer_store_dwordx4 v[48:51], v20, s[44:47], s63 offen offset:2048 sc1
    buffer_store_dwordx4 v[80:83], v2, s[44:47], s63 offen offset:1536 sc1
L_noha:
    v_cvt_pk_bf16_f32 v28, v28, v29
    v_cvt_pk_bf16_f32 v29, v30, v31
    v_cvt_pk_bf16_f32 v30, v32, v33
    v_mfma_f32_32x32x16_bf16 v[108:123], v[140:143], v[136:139], v[108:123]
    v_cvt_pk_bf16_f32 v31, v34, v35
    v_cvt_pk_bf16_f32 v32, v36, v37
    v_cvt_pk_bf16_f32 v33, v38, v39
    v_cvt_pk_bf16_f32 v34, v40, v41
    s_waitcnt lgkmcnt(4)
    v_mfma_f32_32x32x16_bf16 v[92:107], v[148:151], v[156:159], v[92:107]
    ds_read_b128 v[132:135], v14 offset:0
    ds_read_b128 v[136:139], v14 offset:4096
    ds_read_b64_tr_b16 v[140:141], v19 offset:0
    ds_read_b64_tr_b16 v[142:143], v19 offset:512
    v_cvt_pk_bf16_f32 v35, v42, v43
    v_cvt_pk_bf16_f32 v60, v60, v61
    v_cvt_pk_bf16_f32 v61, v62, v63
    v_cvt_pk_bf16_f32 v62, v64, v65
    v_mfma_f32_32x32x16_bf16 v[108:123], v[148:151], v[160:163], v[108:123]
    v_cvt_pk_bf16_f32 v63, v66, v67
    v_cvt_pk_bf16_f32 v64, v68, v69
    v_cvt_pk_bf16_f32 v65, v70, v71
    v_cvt_pk_bf16_f32 v66, v72, v73
    s_waitcnt lgkmcnt(4)
    v_mfma_f32_32x32x16_bf16 v[92:107], v[152:155], v[124:127], v[92:107]
    ds_read_b128 v[156:159], v15 offset:0
    ds_read_b128 v[160:163], v15 offset:4096
    ds_read_b64_tr_b16 v[148:149], v19 offset:2048
    ds_read_b64_tr_b16 v[150:151], v19 offset:2560
    v_cvt_pk_bf16_f32 v67, v74, v75
    v_mfma_f32_32x32x16_bf16 v[108:123], v[152:155], v[128:131], v[108:123]
    s_waitcnt lgkmcnt(4)
    v_mfma_f32_32x32x16_bf16 v[92:107], v[140:143], v[132:135], v[92:107]
    ds_read_b128 v[124:127], v16 offset:0
    ds_read_b128 v[128:131], v16 offset:4096
    ds_read_b64_tr_b16 v[152:153], v19 offset:4096
    ds_read_b64_tr_b16 v[154:155], v19 offset:4608
    v_mfma_f32_32x32x16_bf16 v[108:123], v[140:143], v[136:139], v[108:123]
    s_waitcnt lgkmcnt(4)
    v_mfma_f32_32x32x16_bf16 v[92:107], v[148:151], v[156:159], v[92:107]
    ds_read_b128 v[132:135], v17 offset:0
    ds_read_b128 v[136:139], v17 offset:4096
    ds_read_b64_tr_b16 v[140:141], v19 offset:6144
    ds_read_b64_tr_b16 v[142:143], v19 offset:6656
    v_mfma_f32_32x32x16_bf16 v[108:123], v[148:151], v[160:163], v[108:123]
    s_waitcnt lgkmcnt(4)
    v_mfma_f32_32x32x16_bf16 v[92:107], v[152:155], v[124:127], v[92:107]
    v_mfma_f32_32x32x16_bf16 v[108:123], v[152:155], v[128:131], v[108:123]
    s_waitcnt lgkmcnt(0)
    v_mfma_f32_32x32x16_bf16 v[92:107], v[140:143], v[132:135], v[92:107]
    v_mfma_f32_32x32x16_bf16 v[108:123], v[140:143], v[136:139], v[108:123]
    s_waitcnt lgkmcnt(0)
    s_barrier
    ds_write_b128 v3, v[28:31] offset:0
    ds_write_b128 v3, v[32:35] offset:2048
    ds_write_b128 v4, v[60:63] offset:1024
    ds_write_b128 v4, v[64:67] offset:1536
    ds_write_b128 v3, v[44:47] offset:8192
    ds_write_b128 v3, v[48:51] offset:10240
    ds_write_b128 v4, v[76:79] offset:9216
    ds_write_b128 v4, v[80:83] offset:9728
    s_lshr_b32 s62, s71, 1
    s_add_u32 s62, s62, 65536
    v_add_u32 v3, s62, v8
    v_cvt_pk_bf16_f32 v92, v92, v93
    v_cvt_pk_bf16_f32 v93, v94, v95
    v_cvt_pk_bf16_f32 v94, v96, v97
    v_cvt_pk_bf16_f32 v95, v98, v99
    v_cvt_pk_bf16_f32 v96, v100, v101
    v_cvt_pk_bf16_f32 v97, v102, v103
    v_cvt_pk_bf16_f32 v98, v104, v105
    v_cvt_pk_bf16_f32 v99, v106, v107
    ds_write_b128 v3, v[92:95] offset:0
    ds_write_b128 v3, v[96:99] offset:1024
    v_cvt_pk_bf16_f32 v108, v108, v109
    v_cvt_pk_bf16_f32 v109, v110, v111
    v_cvt_pk_bf16_f32 v110, v112, v113
    v_cvt_pk_bf16_f32 v111, v114, v115
    v_cvt_pk_bf16_f32 v112, v116, v117
    v_cvt_pk_bf16_f32 v113, v118, v119
    v_cvt_pk_bf16_f32 v114, v120, v121
    v_cvt_pk_bf16_f32 v115, v122, v123
    ds_write_b128 v3, v[108:111] offset:4096
    ds_write_b128 v3, v[112:115] offset:5120
    s_waitcnt lgkmcnt(0)
    s_barrier
    v_add_u32 v2, 122880, v8
    v_mov_b32 v4, 0xf149f2ca
    ds_read_b128 v[28:31], v2 offset:0
    ds_read_b128 v[32:35], v2 offset:1024
    ds_read_b128 v[36:39], v2 offset:2048
    ds_read_b128 v[40:43], v2 offset:3072
    ds_read_b128 v[44:47], v2 offset:4096
    ds_read_b128 v[48:51], v2 offset:5120
    s_lshl_b32 s62, s60, 10
    s_add_u32 s62, s62, 65536
    v_add_u32 v10, s62, v8
    s_lshl_b32 s62, s60, 11
    s_add_u32 s63, s62, 73728
    v_add_u32 v11, s63, v8
    v_add_u32 v12, s63, v9
    v_and_b32 v2, 27, v0
    v_cmp_eq_u32 vcc, 16, v2
    v_mov_b32 v3, 0x3f803f80
    v_lshl_add_u32 v13, v21, 14, v9
    v_cndmask_b32 v3, 0, v3, vcc
    v_mov_b32 v16, 0xdddddddd
    v_mov_b32 v17, 1
    s_and_b32 s63, s60, 1
    s_lshl_b32 s63, s63, 9
    v_add_u32 v13, s63, v13
    s_lshl_b32 s72, s27, 7
    s_lshl_b32 s63, s3, 1
    s_add_u32 s72, s72, s63
    s_lshr_b32 s63, s60, 1
    s_add_u32 s72, s72, s63
    s_lshl_b32 s72, s72, 10
    s_add_u32 s72, s72, 6291456
    s_add_u32 s76, s76, s62
    s_sub_u32 s76, s76, 8192
    v_mov_b32 v124, v3
    v_mov_b32 v125, v3
    v_mov_b32 v126, v3
    v_mov_b32 v127, v3
    v_mov_b32 v128, v3
    v_mov_b32 v129, v3
    v_mov_b32 v130, v3
    v_mov_b32 v131, v3
    v_mov_b32 v132, v3
    v_mov_b32 v133, v3
    v_mov_b32 v134, v3
    v_mov_b32 v135, v3
    s_waitcnt vmcnt(0)
    s_mov_b32 s66, 0
L_non_14:
    v_readfirstlane_b32 s64, v6
    v_readfirstlane_b32 s65, v7
    s_add_u32 s66, s66, 1
    s_cmp_gt_u32 s66, 30000
    s_cbranch_scc1 L_nond_15
    s_cmp_eq_u32 s64, 0
    s_cselect_b32 s63, 0, s65
    s_cmp_lg_u32 s63, 0
    s_cbranch_scc1 L_nond_15
    buffer_load_dwordx2 v[6:7], v5, s[48:51], 0 offen sc1
    s_waitcnt vmcnt(0)
    s_branch L_non_14
L_nond_15:
    s_cmp_lg_u32 s82, 1
    s_cbranch_scc1 L_noha2
    s_mov_b64 exec, 1
    buffer_store_dwordx2 v[6:7], v5, s[44:47], s77 offen sc1
    s_mov_b64 exec, -1
L_noha2:
    s_sub_u32 s77, s77, 256
    ds_read_b128 v[108:111], v10 offset:4096
    ds_read_b128 v[112:115], v11 offset:16384
    ds_read_b128 v[116:119], v11 offset:8192
    s_mov_b64 exec, s[68:69]
    ds_read_b128 v[124:127], v12 offset:17408
    ds_read_b128 v[128:131], v12 offset:17920
    ds_read_b128 v[132:135], v12 offset:9728
    s_mov_b64 exec, -1
    s_waitcnt lgkmcnt(4)
    v_mfma_f32_32x32x16_bf16 v[60:75], v[112:115], v[108:111], v[28:43]
    s_waitcnt lgkmcnt(3)
    v_mfma_f32_32x32x16_bf16 v[76:91], v[116:119], v[108:111], v[36:51]
    v_mov_b32 v92, 0
    v_mov_b32 v93, 0
    v_mov_b32 v94, 0
    v_mov_b32 v95, 0
    v_mov_b32 v96, 0
    v_mov_b32 v97, 0
    v_mov_b32 v98, 0
    v_mov_b32 v99, 0
    v_mov_b32 v100, 0
    s_nop 1
    v_max_f32 v14, v60, v61
    v_max3_f32 v15, v62, v63, v64
    v_max3_f32 v14, v14, v65, v66
    v_max3_f32 v15, v15, v67, v68
    v_max3_f32 v14, v14, v69, v70
    v_max3_f32 v15, v15, v71, v72
    v_max3_f32 v14, v14, v73, v74
    v_max3_f32 v15, v15, v75, v84
    v_max3_f32 v14, v14, v85, v86
    v_max3_f32 v15, v15, v87, v88
    v_max3_f32 v14, v14, v89, v90
    v_max3_f32 v14, v14, v15, v91
    v_mov_b32 v15, v14
    s_nop 1
    v_permlane32_swap_b32 v14, v15
    s_nop 1
    v_max_f32 v14, v14, v15
    v_mul_f32 v14, s84, v14
    v_fma_f32 v84, v84, s84, -v14
    v_fma_f32 v85, v85, s84, -v14
    v_fma_f32 v86, v86, s84, -v14
    v_fma_f32 v87, v87, s84, -v14
    v_fma_f32 v88, v88, s84, -v14
    v_fma_f32 v89, v89, s84, -v14
    v_fma_f32 v90, v90, s84, -v14
    v_fma_f32 v91, v91, s84, -v14
    v_fma_f32 v60, v60, s84, -v14
    v_fma_f32 v61, v61, s84, -v14
    v_fma_f32 v62, v62, s84, -v14
    v_fma_f32 v63, v63, s84, -v14
    v_fma_f32 v64, v64, s84, -v14
    v_fma_f32 v65, v65, s84, -v14
    v_fma_f32 v66, v66, s84, -v14
    v_fma_f32 v67, v67, s84, -v14
    v_fma_f32 v68, v68, s84, -v14
    v_fma_f32 v69, v69, s84, -v14
    v_fma_f32 v70, v70, s84, -v14
    v_fma_f32 v71, v71, s84, -v14
    v_fma_f32 v72, v72, s84, -v14
    v_fma_f32 v73, v73, s84, -v14
    v_fma_f32 v74, v74, s84, -v14
    v_fma_f32 v75, v75, s84, -v14
    s_waitcnt lgkmcnt(0)
    v_exp_f32 v84, v84
    v_exp_f32 v85, v85
    v_exp_f32 v86, v86
    v_exp_f32 v87, v87
    v_exp_f32 v88, v88
    v_exp_f32 v89, v89
    v_exp_f32 v90, v90
    v_exp_f32 v91, v91
    v_exp_f32 v60, v60
    v_exp_f32 v61, v61
    v_smfmac_f32_32x32x32_bf16 v[92:107], v[132:135], v[84:91], v16
    v_exp_f32 v62, v62
    v_exp_f32 v63, v63
    v_exp_f32 v64, v64
    v_exp_f32 v65, v65
    v_exp_f32 v66, v66
    v_exp_f32 v67, v67
    v_exp_f32 v68, v68
    v_exp_f32 v69, v69
    v_smfmac_f32_32x32x32_bf16 v[92:107], v[124:127], v[60:67], v16
    v_exp_f32 v70, v70
    v_exp_f32 v71, v71
    v_exp_f32 v72, v72
    v_exp_f32 v73, v73
    v_exp_f32 v74, v74
    v_exp_f32 v75, v75
    s_nop 1
    v_smfmac_f32_32x32x32_bf16 v[92:107], v[128:131], v[68:75], v16
    s_nop 11
    v_rcp_f32 v15, v100
    s_nop 0
    v_mul_f32 v92, v92, v15
    v_mul_f32 v93, v93, v15
    v_mul_f32 v94, v94, v15
    v_mul_f32 v95, v95, v15
    v_mul_f32 v96, v96, v15
    v_mul_f32 v97, v97, v15
    v_mul_f32 v98, v98, v15
    v_mul_f32 v99, v99, v15
    v_cvt_pk_bf16_f32 v120, v92, v93
    v_cvt_pk_bf16_f32 v121, v94, v95
    v_cvt_pk_bf16_f32 v122, v96, v97
    v_cvt_pk_bf16_f32 v123, v98, v99
    s_add_u32 s63, s72, 32768
    buffer_store_dwordx4 v[120:123], v13, s[44:47], s63 offen sc1
    ds_read_b128 v[108:111], v10 offset:0
    ds_read_b128 v[112:115], v11 offset:8192
    s_mov_b64 exec, s[68:69]
    ds_read_b128 v[124:127], v12 offset:9216
    ds_read_b128 v[128:131], v12 offset:9728
    s_mov_b64 exec, -1
    s_waitcnt lgkmcnt(0)
    s_cmp_eq_u32 s27, 0
    s_cbranch_scc1 L_first
    s_mov_b64 exec, 0x1
    buffer_load_dwordx2 v[140:141], v5, s[44:47], s77 offen sc1
    s_mov_b64 exec, -1
    s_mov_b32 s66, 0
    s_mov_b64 exec, 0x1
    s_waitcnt vmcnt(0)
    s_branch L_pollc_18
L_poll_16:
    buffer_load_dwordx2 v[140:141], v5, s[44:47], s77 offen sc1
    s_waitcnt vmcnt(0)
L_pollc_18:
    v_cmp_eq_u64 vcc, s[64:65], v[140:141]
    s_add_u32 s66, s66, 1
    s_cmp_eq_u64 vcc, exec
    s_cbranch_scc1 L_polld_17
    s_cmp_le_u32 s66, 30000
    s_cbranch_scc1 L_poll_16
L_polld_17:
    s_mov_b64 exec, -1
    buffer_load_dwordx4 v[116:119], v8, s[44:47], s76 offen sc1
    s_mov_b64 exec, s[68:69]
    buffer_load_dwordx4 v[132:135], v9, s[44:47], s76 offen offset:1536 sc1
    s_mov_b64 exec, -1
    s_waitcnt vmcnt(0)
    s_branch L_first2
L_first:
    v_mov_b32 v44, v4
    v_mov_b32 v45, v4
    v_mov_b32 v46, v4
    v_mov_b32 v47, v4
    v_mov_b32 v48, v4
    v_mov_b32 v49, v4
    v_mov_b32 v50, v4
    v_mov_b32 v51, v4
    s_nop 1
L_first2:
    v_mfma_f32_32x32x16_bf16 v[60:75], v[112:115], v[108:111], v[28:43]
    v_mfma_f32_32x32x16_bf16 v[76:91], v[116:119], v[108:111], v[36:51]
    v_mov_b32 v92, 0
    v_mov_b32 v93, 0
    v_mov_b32 v94, 0
    v_mov_b32 v95, 0
    v_mov_b32 v96, 0
    v_mov_b32 v97, 0
    v_mov_b32 v98, 0
    v_mov_b32 v99, 0
    v_mov_b32 v100, 0
    s_nop 1
    v_max_f32 v14, v60, v61
    v_max3_f32 v15, v62, v63, v64
    v_max3_f32 v14, v14, v65, v66
    v_max3_f32 v15, v15, v67, v68
    v_max3_f32 v14, v14, v69, v70
    v_max3_f32 v15, v15, v71, v72
    v_max3_f32 v14, v14, v73, v74
    v_max3_f32 v15, v15, v75, v84
    v_max3_f32 v14, v14, v85, v86
    v_max3_f32 v15, v15, v87, v88
    v_max3_f32 v14, v14, v89, v90
    v_max3_f32 v14, v14, v15, v91
    v_mov_b32 v15, v14
    s_nop 1
    v_permlane32_swap_b32 v14, v15
    s_nop 1
    v_max_f32 v14, v14, v15
    v_mul_f32 v14, s84, v14
    v_fma_f32 v84, v84, s84, -v14
    v_fma_f32 v85, v85, s84, -v14
    v_fma_f32 v86, v86, s84, -v14
    v_fma_f32 v87, v87, s84, -v14
    v_fma_f32 v88, v88, s84, -v14
    v_fma_f32 v89, v89, s84, -v14
    v_fma_f32 v90, v90, s84, -v14
    v_fma_f32 v91, v91, s84, -v14
    v_fma_f32 v60, v60, s84, -v14
    v_fma_f32 v61, v61, s84, -v14
    v_fma_f32 v62, v62, s84, -v14
    v_fma_f32 v63, v63, s84, -v14
    v_fma_f32 v64, v64, s84, -v14
    v_fma_f32 v65, v65, s84, -v14
    v_fma_f32 v66, v66, s84, -v14
    v_fma_f32 v67, v67, s84, -v14
    v_fma_f32 v68, v68, s84, -v14
    v_fma_f32 v69, v69, s84, -v14
    v_fma_f32 v70, v70, s84, -v14
    v_fma_f32 v71, v71, s84, -v14
    v_fma_f32 v72, v72, s84, -v14
    v_fma_f32 v73, v73, s84, -v14
    v_fma_f32 v74, v74, s84, -v14
    v_fma_f32 v75, v75, s84, -v14
    v_exp_f32 v84, v84
    v_exp_f32 v85, v85
    v_exp_f32 v86, v86
    v_exp_f32 v87, v87
    v_exp_f32 v88, v88
    v_exp_f32 v89, v89
    v_exp_f32 v90, v90
    v_exp_f32 v91, v91
    v_exp_f32 v60, v60
    v_exp_f32 v61, v61
    v_smfmac_f32_32x32x32_bf16 v[92:107], v[132:135], v[84:91], v16
    v_exp_f32 v62, v62
    v_exp_f32 v63, v63
    v_exp_f32 v64, v64
    v_exp_f32 v65, v65
    v_exp_f32 v66, v66
    v_exp_f32 v67, v67
    v_exp_f32 v68, v68
    v_exp_f32 v69, v69
    v_smfmac_f32_32x32x32_bf16 v[92:107], v[124:127], v[60:67], v16
    v_exp_f32 v70, v70
    v_exp_f32 v71, v71
    v_exp_f32 v72, v72
    v_exp_f32 v73, v73
    v_exp_f32 v74, v74
    v_exp_f32 v75, v75
    s_nop 1
    v_smfmac_f32_32x32x32_bf16 v[92:107], v[128:131], v[68:75], v16
    s_nop 11
    v_rcp_f32 v15, v100
    s_nop 0
    v_mul_f32 v92, v92, v15
    v_mul_f32 v93, v93, v15
    v_mul_f32 v94, v94, v15
    v_mul_f32 v95, v95, v15
    v_mul_f32 v96, v96, v15
    v_mul_f32 v97, v97, v15
    v_mul_f32 v98, v98, v15
    v_mul_f32 v99, v99, v15
    v_cvt_pk_bf16_f32 v152, v92, v93
    v_cvt_pk_bf16_f32 v153, v94, v95
    v_cvt_pk_bf16_f32 v154, v96, v97
    v_cvt_pk_bf16_f32 v155, v98, v99
    s_add_u32 s63, s72, 0
    buffer_store_dwordx4 v[152:155], v13, s[44:47], s63 offen sc1
    s_lshl_b32 s63, s27, 3
    s_add_u32 s63, s63, s3
    s_lshl_b32 s63, s63, 7
    s_add_u32 s63, s63, 8519680
    s_waitcnt vmcnt(0)
    s_mov_b64 exec, 1
    ds_add_u32 v24, v17 offset:48
    s_mov_b64 exec, -1
    s_mov_b32 s66, 0
L_cnt:
    ds_read_b32 v140, v24 offset:48
    s_add_u32 s66, s66, 1
    s_waitcnt lgkmcnt(0)
    v_readfirstlane_b32 s62, v140
    s_cmp_gt_u32 s66, 240000
    s_cbranch_scc1 L_cntd
    s_cmp_lt_u32 s62, 12
    s_cbranch_scc1 L_cnt
L_cntd:
    s_cmp_lg_u32 s60, 0
    s_cbranch_scc1 L_wo
    s_mov_b64 exec, 1
    buffer_store_dwordx2 v[6:7], v5, s[44:47], s63 offen sc1
    s_mov_b64 exec, -1
L_wo:
    s_mov_b32 s66, 0
L_ws_19:
    ds_read_b32 v2, v24 offset:44
    s_add_u32 s66, s66, 1
    s_waitcnt lgkmcnt(0)
    v_readfirstlane_b32 s62, v2
    s_cmp_gt_u32 s66, 240000
    s_cbranch_scc1 L_wsd_20
    s_cmp_eq_u32 s62, 0
    s_cbranch_scc1 L_ws_19
L_wsd_20:
    s_lshr_b32 s62, s24, 1
    s_lshl_b32 s62, s62, 10
    s_add_u32 s62, s62, 8519680
    s_mov_b32 s52, s14
    s_mov_b32 s53, s15
    s_mov_b32 s54, 524288
    s_mov_b32 s55, 0x00020000
    s_mov_b32 s36, s8
    s_mov_b32 s37, s9
    s_mov_b32 s38, 524288
    s_mov_b32 s39, 0x00020000
    s_mov_b32 s56, s16
    s_mov_b32 s57, s17
    s_mov_b32 s58, 4194304
    s_mov_b32 s59, 0x00020000
    v_lshrrev_b32 v2, 3, v0
    v_and_b32 v3, 6, v2
    v_xor_b32 v3, v3, v0
    v_and_b32 v3, 7, v3
    v_lshlrev_b32 v2, 10, v2
    v_lshl_add_u32 v2, v3, 4, v2
    s_lshl_b32 s73, s60, 17
    s_lshl_b32 s74, s23, 7
    s_add_u32 s74, s74, s73
    s_lshl_b32 s75, s60, 14
    s_add_u32 m0, s75, 0
    s_add_u32 s79, s74, 0
    buffer_load_dwordx4 v2, s[52:55], s79 offen lds
    s_add_u32 m0, s75, 1024
    s_add_u32 s79, s74, 8192
    buffer_load_dwordx4 v2, s[52:55], s79 offen lds
    s_waitcnt vmcnt(1)
    s_add_u32 m0, s75, 2048
    s_add_u32 s79, s74, 16384
    buffer_load_dwordx4 v2, s[52:55], s79 offen lds
    s_add_u32 m0, s75, 3072
    s_add_u32 s79, s74, 24576
    buffer_load_dwordx4 v2, s[52:55], s79 offen lds
    s_waitcnt vmcnt(1)
    s_add_u32 m0, s75, 4096
    s_add_u32 s79, s74, 32768
    buffer_load_dwordx4 v2, s[52:55], s79 offen lds
    s_add_u32 m0, s75, 5120
    s_add_u32 s79, s74, 40960
    buffer_load_dwordx4 v2, s[52:55], s79 offen lds
    s_waitcnt vmcnt(1)
    s_add_u32 m0, s75, 6144
    s_add_u32 s79, s74, 49152
    buffer_load_dwordx4 v2, s[52:55], s79 offen lds
    s_add_u32 m0, s75, 7168
    s_add_u32 s79, s74, 57344
    buffer_load_dwordx4 v2, s[52:55], s79 offen lds
    s_waitcnt vmcnt(1)
    s_add_u32 m0, s75, 8192
    s_add_u32 s79, s74, 65536
    buffer_load_dwordx4 v2, s[52:55], s79 offen lds
    s_add_u32 m0, s75, 9216
    s_add_u32 s79, s74, 73728
    buffer_load_dwordx4 v2, s[52:55], s79 offen lds
    s_waitcnt vmcnt(1)
    s_add_u32 m0, s75, 10240
    s_add_u32 s79, s74, 81920
    buffer_load_dwordx4 v2, s[52:55], s79 offen lds
    s_add_u32 m0, s75, 11264
    s_add_u32 s79, s74, 90112
    buffer_load_dwordx4 v2, s[52:55], s79 offen lds
    s_waitcnt vmcnt(1)
    s_add_u32 m0, s75, 12288
    s_add_u32 s79, s74, 98304
    buffer_load_dwordx4 v2, s[52:55], s79 offen lds
    s_add_u32 m0, s75, 13312
    s_add_u32 s79, s74, 106496
    buffer_load_dwordx4 v2, s[52:55], s79 offen lds
    s_waitcnt vmcnt(1)
    s_add_u32 m0, s75, 14336
    s_add_u32 s79, s74, 114688
    buffer_load_dwordx4 v2, s[52:55], s79 offen lds
    s_add_u32 m0, s75, 15360
    s_add_u32 s79, s74, 122880
    buffer_load_dwordx4 v2, s[52:55], s79 offen lds
    s_waitcnt vmcnt(1)
L_woa:
    s_add_u32 m0, s75, 65536
    s_add_u32 s79, s74, 0
    buffer_load_dwordx4 v2, s[36:39], s79 offen lds
    s_add_u32 m0, s75, 66560
    s_add_u32 s79, s74, 8192
    buffer_load_dwordx4 v2, s[36:39], s79 offen lds
    s_waitcnt vmcnt(1)
    s_add_u32 m0, s75, 67584
    s_add_u32 s79, s74, 16384
    buffer_load_dwordx4 v2, s[36:39], s79 offen lds
    s_add_u32 m0, s75, 68608
    s_add_u32 s79, s74, 24576
    buffer_load_dwordx4 v2, s[36:39], s79 offen lds
    s_waitcnt vmcnt(1)
    s_add_u32 m0, s75, 69632
    s_add_u32 s79, s74, 32768
    buffer_load_dwordx4 v2, s[36:39], s79 offen lds
    s_add_u32 m0, s75, 70656
    s_add_u32 s79, s74, 40960
    buffer_load_dwordx4 v2, s[36:39], s79 offen lds
    s_waitcnt vmcnt(1)
    s_add_u32 m0, s75, 71680
    s_add_u32 s79, s74, 49152
    buffer_load_dwordx4 v2, s[36:39], s79 offen lds
    s_add_u32 m0, s75, 72704
    s_add_u32 s79, s74, 57344
    buffer_load_dwordx4 v2, s[36:39], s79 offen lds
    s_waitcnt vmcnt(1)
    s_add_u32 m0, s75, 73728
    s_add_u32 s79, s74, 65536
    buffer_load_dwordx4 v2, s[36:39], s79 offen lds
    s_add_u32 m0, s75, 74752
    s_add_u32 s79, s74, 73728
    buffer_load_dwordx4 v2, s[36:39], s79 offen lds
    s_waitcnt vmcnt(1)
    s_add_u32 m0, s75, 75776
    s_add_u32 s79, s74, 81920
    buffer_load_dwordx4 v2, s[36:39], s79 offen lds
    s_add_u32 m0, s75, 76800
    s_add_u32 s79, s74, 90112
    buffer_load_dwordx4 v2, s[36:39], s79 offen lds
    s_waitcnt vmcnt(1)
    s_add_u32 m0, s75, 77824
    s_add_u32 s79, s74, 98304
    buffer_load_dwordx4 v2, s[36:39], s79 offen lds
    s_add_u32 m0, s75, 78848
    s_add_u32 s79, s74, 106496
    buffer_load_dwordx4 v2, s[36:39], s79 offen lds
    s_waitcnt vmcnt(1)
    s_add_u32 m0, s75, 79872
    s_add_u32 s79, s74, 114688
    buffer_load_dwordx4 v2, s[36:39], s79 offen lds
    s_add_u32 m0, s75, 80896
    s_add_u32 s79, s74, 122880
    buffer_load_dwordx4 v2, s[36:39], s79 offen lds
    s_waitcnt vmcnt(1)
    v_and_b32 v10, 15, v0
    v_lshlrev_b32 v18, 11, v10
    v_lshlrev_b32 v10, 7, v10
    v_lshrrev_b32 v2, 4, v0
    v_lshl_add_u32 v18, v2, 3, v18
    s_mov_b64 exec, 0xff
    buffer_load_dwordx2 v[12:13], v10, s[44:47], s62 offen sc1
    s_mov_b64 exec, -1
    s_mov_b32 s66, 0
    s_mov_b64 exec, 0xff
    s_waitcnt vmcnt(0)
    s_branch L_pollc_23
L_poll_21:
    buffer_load_dwordx2 v[12:13], v10, s[44:47], s62 offen sc1
    s_waitcnt vmcnt(0)
L_pollc_23:
    v_cmp_eq_u64 vcc, s[64:65], v[12:13]
    s_add_u32 s66, s66, 1
    s_cmp_eq_u64 vcc, exec
    s_cbranch_scc1 L_polld_22
    s_cmp_le_u32 s66, 30000
    s_cbranch_scc1 L_poll_21
L_polld_22:
    s_mov_b64 exec, -1
    s_lshl_b32 s71, s24, 2
    s_add_u32 s71, s71, s60
    s_lshl_b32 s73, s71, 14
    s_add_u32 s73, s73, 6291456
    buffer_load_dwordx4 v[20:23], v8, s[44:47], s73 offen offset:0 sc1
    buffer_load_dwordx4 v[24:27], v8, s[44:47], s73 offen offset:1024 sc1
    s_waitcnt vmcnt(1)
    buffer_load_dwordx4 v[28:31], v8, s[44:47], s73 offen offset:2048 sc1
    buffer_load_dwordx4 v[32:35], v8, s[44:47], s73 offen offset:3072 sc1
    s_waitcnt vmcnt(1)
    s_add_u32 s73, s73, 4096
    buffer_load_dwordx4 v[36:39], v8, s[44:47], s73 offen offset:0 sc1
    buffer_load_dwordx4 v[40:43], v8, s[44:47], s73 offen offset:1024 sc1
    s_waitcnt vmcnt(1)
    buffer_load_dwordx4 v[44:47], v8, s[44:47], s73 offen offset:2048 sc1
    buffer_load_dwordx4 v[48:51], v8, s[44:47], s73 offen offset:3072 sc1
    s_waitcnt vmcnt(1)
    s_add_u32 s73, s73, 4096
    buffer_load_dwordx4 v[52:55], v8, s[44:47], s73 offen offset:0 sc1
    buffer_load_dwordx4 v[56:59], v8, s[44:47], s73 offen offset:1024 sc1
    s_waitcnt vmcnt(1)
    buffer_load_dwordx4 v[60:63], v8, s[44:47], s73 offen offset:2048 sc1
    buffer_load_dwordx4 v[64:67], v8, s[44:47], s73 offen offset:3072 sc1
    s_waitcnt vmcnt(1)
    s_add_u32 s73, s73, 4096
    buffer_load_dwordx4 v[68:71], v8, s[44:47], s73 offen offset:0 sc1
    buffer_load_dwordx4 v[72:75], v8, s[44:47], s73 offen offset:1024 sc1
    s_waitcnt vmcnt(1)
    buffer_load_dwordx4 v[76:79], v8, s[44:47], s73 offen offset:2048 sc1
    buffer_load_dwordx4 v[80:83], v8, s[44:47], s73 offen offset:3072 sc1
    s_waitcnt vmcnt(1)
    v_lshrrev_b32 v2, 2, v0
    v_and_b32 v2, 7, v2
    v_lshrrev_b32 v3, 5, v0
    v_lshl_add_u32 v3, v3, 4, v2
    v_lshlrev_b32 v3, 7, v3
    v_and_b32 v2, 6, v2
    v_bfe_u32 v14, v0, 1, 1
    v_xor_b32 v2, v2, v14
    v_lshl_add_u32 v3, v2, 4, v3
    v_and_b32 v2, 1, v0
    v_lshl_add_u32 v14, v2, 3, v3
    v_add_u32 v14, 65536, v14
    v_xor_b32 v15, 32, v14
    v_xor_b32 v16, 64, v14
    v_xor_b32 v17, 96, v14
    s_lshl_b32 s73, s71, 15
    s_lshl_b32 s74, s23, 7
    s_add_u32 s73, s73, s74
    s_waitcnt vmcnt(0)
    s_setprio 0
    s_barrier
    ds_read_b64_tr_b16 v[84:85], v14 offset:0
    ds_read_b64_tr_b16 v[86:87], v14 offset:1024
    ds_read_b64_tr_b16 v[88:89], v15 offset:0
    ds_read_b64_tr_b16 v[90:91], v15 offset:1024
    ds_read_b64_tr_b16 v[92:93], v16 offset:0
    ds_read_b64_tr_b16 v[94:95], v16 offset:1024
    ds_read_b64_tr_b16 v[96:97], v17 offset:0
    ds_read_b64_tr_b16 v[98:99], v17 offset:1024
    ds_read_b64_tr_b16 v[100:101], v14 offset:4096
    ds_read_b64_tr_b16 v[102:103], v14 offset:5120
    ds_read_b64_tr_b16 v[104:105], v15 offset:4096
    ds_read_b64_tr_b16 v[106:107], v15 offset:5120
    s_waitcnt lgkmcnt(10)
    v_mfma_f32_16x16x32_bf16 v[132:135], v[84:87], v[20:23], 0
    ds_read_b64_tr_b16 v[108:109], v16 offset:4096
    ds_read_b64_tr_b16 v[110:111], v16 offset:5120
    s_waitcnt lgkmcnt(10)
    v_mfma_f32_16x16x32_bf16 v[136:139], v[88:91], v[20:23], 0
    ds_read_b64_tr_b16 v[112:113], v17 offset:4096
    ds_read_b64_tr_b16 v[114:115], v17 offset:5120
    s_waitcnt lgkmcnt(10)
    v_mfma_f32_16x16x32_bf16 v[140:143], v[92:95], v[20:23], 0
    ds_read_b64_tr_b16 v[116:117], v14 offset:8192
    ds_read_b64_tr_b16 v[118:119], v14 offset:9216
    s_waitcnt lgkmcnt(10)
    v_mfma_f32_16x16x32_bf16 v[144:147], v[96:99], v[20:23], 0
    ds_read_b64_tr_b16 v[120:121], v15 offset:8192
    ds_read_b64_tr_b16 v[122:123], v15 offset:9216
    s_waitcnt lgkmcnt(10)
    v_mfma_f32_16x16x32_bf16 v[132:135], v[100:103], v[24:27], v[132:135]
    ds_read_b64_tr_b16 v[124:125], v16 offset:8192
    ds_read_b64_tr_b16 v[126:127], v16 offset:9216
    s_waitcnt lgkmcnt(10)
    v_mfma_f32_16x16x32_bf16 v[136:139], v[104:107], v[24:27], v[136:139]
    ds_read_b64_tr_b16 v[128:129], v17 offset:8192
    ds_read_b64_tr_b16 v[130:131], v17 offset:9216
    s_waitcnt lgkmcnt(10)
    v_mfma_f32_16x16x32_bf16 v[140:143], v[108:111], v[24:27], v[140:143]
    ds_read_b64_tr_b16 v[84:85], v14 offset:12288
    ds_read_b64_tr_b16 v[86:87], v14 offset:13312
    s_waitcnt lgkmcnt(10)
    v_mfma_f32_16x16x32_bf16 v[144:147], v[112:115], v[24:27], v[144:147]
    ds_read_b64_tr_b16 v[88:89], v15 offset:12288
    ds_read_b64_tr_b16 v[90:91], v15 offset:13312
    s_waitcnt lgkmcnt(10)
    v_mfma_f32_16x16x32_bf16 v[132:135], v[116:119], v[28:31], v[132:135]
    ds_read_b64_tr_b16 v[92:93], v16 offset:12288
    ds_read_b64_tr_b16 v[94:95], v16 offset:13312
    s_waitcnt lgkmcnt(10)
    v_mfma_f32_16x16x32_bf16 v[136:139], v[120:123], v[28:31], v[136:139]
    ds_read_b64_tr_b16 v[96:97], v17 offset:12288
    ds_read_b64_tr_b16 v[98:99], v17 offset:13312
    s_waitcnt lgkmcnt(10)
    v_mfma_f32_16x16x32_bf16 v[140:143], v[124:127], v[28:31], v[140:143]
    ds_read_b64_tr_b16 v[100:101], v14 offset:16384
    ds_read_b64_tr_b16 v[102:103], v14 offset:17408
    s_waitcnt lgkmcnt(10)
    v_mfma_f32_16x16x32_bf16 v[144:147], v[128:131], v[28:31], v[144:147]
    ds_read_b64_tr_b16 v[104:105], v15 offset:16384
    ds_read_b64_tr_b16 v[106:107], v15 offset:17408
    s_waitcnt lgkmcnt(10)
    v_mfma_f32_16x16x32_bf16 v[132:135], v[84:87], v[32:35], v[132:135]
    ds_read_b64_tr_b16 v[108:109], v16 offset:16384
    ds_read_b64_tr_b16 v[110:111], v16 offset:17408
    s_waitcnt lgkmcnt(10)
    v_mfma_f32_16x16x32_bf16 v[136:139], v[88:91], v[32:35], v[136:139]
    ds_read_b64_tr_b16 v[112:113], v17 offset:16384
    ds_read_b64_tr_b16 v[114:115], v17 offset:17408
    s_waitcnt lgkmcnt(10)
    v_mfma_f32_16x16x32_bf16 v[140:143], v[92:95], v[32:35], v[140:143]
    ds_read_b64_tr_b16 v[116:117], v14 offset:20480
    ds_read_b64_tr_b16 v[118:119], v14 offset:21504
    s_waitcnt lgkmcnt(10)
    v_mfma_f32_16x16x32_bf16 v[144:147], v[96:99], v[32:35], v[144:147]
    ds_read_b64_tr_b16 v[120:121], v15 offset:20480
    ds_read_b64_tr_b16 v[122:123], v15 offset:21504
    s_waitcnt lgkmcnt(10)
    v_mfma_f32_16x16x32_bf16 v[132:135], v[100:103], v[36:39], v[132:135]
    ds_read_b64_tr_b16 v[124:125], v16 offset:20480
    ds_read_b64_tr_b16 v[126:127], v16 offset:21504
    s_waitcnt lgkmcnt(10)
    v_mfma_f32_16x16x32_bf16 v[136:139], v[104:107], v[36:39], v[136:139]
    ds_read_b64_tr_b16 v[128:129], v17 offset:20480
    ds_read_b64_tr_b16 v[130:131], v17 offset:21504
    s_waitcnt lgkmcnt(10)
    v_mfma_f32_16x16x32_bf16 v[140:143], v[108:111], v[36:39], v[140:143]
    ds_read_b64_tr_b16 v[84:85], v14 offset:24576
    ds_read_b64_tr_b16 v[86:87], v14 offset:25600
    s_waitcnt lgkmcnt(10)
    v_mfma_f32_16x16x32_bf16 v[144:147], v[112:115], v[36:39], v[144:147]
    ds_read_b64_tr_b16 v[88:89], v15 offset:24576
    ds_read_b64_tr_b16 v[90:91], v15 offset:25600
    s_waitcnt lgkmcnt(10)
    v_mfma_f32_16x16x32_bf16 v[132:135], v[116:119], v[40:43], v[132:135]
    ds_read_b64_tr_b16 v[92:93], v16 offset:24576
    ds_read_b64_tr_b16 v[94:95], v16 offset:25600
    s_waitcnt lgkmcnt(10)
    v_mfma_f32_16x16x32_bf16 v[136:139], v[120:123], v[40:43], v[136:139]
    ds_read_b64_tr_b16 v[96:97], v17 offset:24576
    ds_read_b64_tr_b16 v[98:99], v17 offset:25600
    s_waitcnt lgkmcnt(10)
    v_mfma_f32_16x16x32_bf16 v[140:143], v[124:127], v[40:43], v[140:143]
    ds_read_b64_tr_b16 v[100:101], v14 offset:28672
    ds_read_b64_tr_b16 v[102:103], v14 offset:29696
    s_waitcnt lgkmcnt(10)
    v_mfma_f32_16x16x32_bf16 v[144:147], v[128:131], v[40:43], v[144:147]
    ds_read_b64_tr_b16 v[104:105], v15 offset:28672
    ds_read_b64_tr_b16 v[106:107], v15 offset:29696
    s_waitcnt lgkmcnt(10)
    v_mfma_f32_16x16x32_bf16 v[132:135], v[84:87], v[44:47], v[132:135]
    ds_read_b64_tr_b16 v[108:109], v16 offset:28672
    ds_read_b64_tr_b16 v[110:111], v16 offset:29696
    s_waitcnt lgkmcnt(10)
    v_mfma_f32_16x16x32_bf16 v[136:139], v[88:91], v[44:47], v[136:139]
    ds_read_b64_tr_b16 v[112:113], v17 offset:28672
    ds_read_b64_tr_b16 v[114:115], v17 offset:29696
    s_waitcnt lgkmcnt(10)
    v_mfma_f32_16x16x32_bf16 v[140:143], v[92:95], v[44:47], v[140:143]
    ds_read_b64_tr_b16 v[116:117], v14 offset:32768
    ds_read_b64_tr_b16 v[118:119], v14 offset:33792
    s_waitcnt lgkmcnt(10)
    v_mfma_f32_16x16x32_bf16 v[144:147], v[96:99], v[44:47], v[144:147]
    ds_read_b64_tr_b16 v[120:121], v15 offset:32768
    ds_read_b64_tr_b16 v[122:123], v15 offset:33792
    s_waitcnt lgkmcnt(10)
    v_mfma_f32_16x16x32_bf16 v[132:135], v[100:103], v[48:51], v[132:135]
    ds_read_b64_tr_b16 v[124:125], v16 offset:32768
    ds_read_b64_tr_b16 v[126:127], v16 offset:33792
    s_waitcnt lgkmcnt(10)
    v_mfma_f32_16x16x32_bf16 v[136:139], v[104:107], v[48:51], v[136:139]
    ds_read_b64_tr_b16 v[128:129], v17 offset:32768
    ds_read_b64_tr_b16 v[130:131], v17 offset:33792
    s_waitcnt lgkmcnt(10)
    v_mfma_f32_16x16x32_bf16 v[140:143], v[108:111], v[48:51], v[140:143]
    ds_read_b64_tr_b16 v[84:85], v14 offset:36864
    ds_read_b64_tr_b16 v[86:87], v14 offset:37888
    s_waitcnt lgkmcnt(10)
    v_mfma_f32_16x16x32_bf16 v[144:147], v[112:115], v[48:51], v[144:147]
    ds_read_b64_tr_b16 v[88:89], v15 offset:36864
    ds_read_b64_tr_b16 v[90:91], v15 offset:37888
    s_waitcnt lgkmcnt(10)
    v_mfma_f32_16x16x32_bf16 v[132:135], v[116:119], v[52:55], v[132:135]
    ds_read_b64_tr_b16 v[92:93], v16 offset:36864
    ds_read_b64_tr_b16 v[94:95], v16 offset:37888
    s_waitcnt lgkmcnt(10)
    v_mfma_f32_16x16x32_bf16 v[136:139], v[120:123], v[52:55], v[136:139]
    ds_read_b64_tr_b16 v[96:97], v17 offset:36864
    ds_read_b64_tr_b16 v[98:99], v17 offset:37888
    s_waitcnt lgkmcnt(10)
    v_mfma_f32_16x16x32_bf16 v[140:143], v[124:127], v[52:55], v[140:143]
    ds_read_b64_tr_b16 v[100:101], v14 offset:40960
    ds_read_b64_tr_b16 v[102:103], v14 offset:41984
    s_waitcnt lgkmcnt(10)
    v_mfma_f32_16x16x32_bf16 v[144:147], v[128:131], v[52:55], v[144:147]
    ds_read_b64_tr_b16 v[104:105], v15 offset:40960
    ds_read_b64_tr_b16 v[106:107], v15 offset:41984
    s_waitcnt lgkmcnt(10)
    v_mfma_f32_16x16x32_bf16 v[132:135], v[84:87], v[56:59], v[132:135]
    ds_read_b64_tr_b16 v[108:109], v16 offset:40960
    ds_read_b64_tr_b16 v[110:111], v16 offset:41984
    s_waitcnt lgkmcnt(10)
    v_mfma_f32_16x16x32_bf16 v[136:139], v[88:91], v[56:59], v[136:139]
    ds_read_b64_tr_b16 v[112:113], v17 offset:40960
    ds_read_b64_tr_b16 v[114:115], v17 offset:41984
    s_waitcnt lgkmcnt(10)
    v_mfma_f32_16x16x32_bf16 v[140:143], v[92:95], v[56:59], v[140:143]
    ds_read_b64_tr_b16 v[116:117], v14 offset:45056
    ds_read_b64_tr_b16 v[118:119], v14 offset:46080
    s_waitcnt lgkmcnt(10)
    v_mfma_f32_16x16x32_bf16 v[144:147], v[96:99], v[56:59], v[144:147]
    ds_read_b64_tr_b16 v[120:121], v15 offset:45056
    ds_read_b64_tr_b16 v[122:123], v15 offset:46080
    s_waitcnt lgkmcnt(10)
    v_mfma_f32_16x16x32_bf16 v[132:135], v[100:103], v[60:63], v[132:135]
    ds_read_b64_tr_b16 v[124:125], v16 offset:45056
    ds_read_b64_tr_b16 v[126:127], v16 offset:46080
    s_waitcnt lgkmcnt(10)
    v_mfma_f32_16x16x32_bf16 v[136:139], v[104:107], v[60:63], v[136:139]
    ds_read_b64_tr_b16 v[128:129], v17 offset:45056
    ds_read_b64_tr_b16 v[130:131], v17 offset:46080
    s_waitcnt lgkmcnt(10)
    v_mfma_f32_16x16x32_bf16 v[140:143], v[108:111], v[60:63], v[140:143]
    ds_read_b64_tr_b16 v[84:85], v14 offset:49152
    ds_read_b64_tr_b16 v[86:87], v14 offset:50176
    s_waitcnt lgkmcnt(10)
    v_mfma_f32_16x16x32_bf16 v[144:147], v[112:115], v[60:63], v[144:147]
    ds_read_b64_tr_b16 v[88:89], v15 offset:49152
    ds_read_b64_tr_b16 v[90:91], v15 offset:50176
    s_waitcnt lgkmcnt(10)
    v_mfma_f32_16x16x32_bf16 v[132:135], v[116:119], v[64:67], v[132:135]
    ds_read_b64_tr_b16 v[92:93], v16 offset:49152
    ds_read_b64_tr_b16 v[94:95], v16 offset:50176
    s_waitcnt lgkmcnt(10)
    v_mfma_f32_16x16x32_bf16 v[136:139], v[120:123], v[64:67], v[136:139]
    ds_read_b64_tr_b16 v[96:97], v17 offset:49152
    ds_read_b64_tr_b16 v[98:99], v17 offset:50176
    s_waitcnt lgkmcnt(10)
    v_mfma_f32_16x16x32_bf16 v[140:143], v[124:127], v[64:67], v[140:143]
    ds_read_b64_tr_b16 v[100:101], v14 offset:53248
    ds_read_b64_tr_b16 v[102:103], v14 offset:54272
    s_waitcnt lgkmcnt(10)
    v_mfma_f32_16x16x32_bf16 v[144:147], v[128:131], v[64:67], v[144:147]
    ds_read_b64_tr_b16 v[104:105], v15 offset:53248
    ds_read_b64_tr_b16 v[106:107], v15 offset:54272
    s_waitcnt lgkmcnt(10)
    v_mfma_f32_16x16x32_bf16 v[132:135], v[84:87], v[68:71], v[132:135]
    ds_read_b64_tr_b16 v[108:109], v16 offset:53248
    ds_read_b64_tr_b16 v[110:111], v16 offset:54272
    s_waitcnt lgkmcnt(10)
    v_mfma_f32_16x16x32_bf16 v[136:139], v[88:91], v[68:71], v[136:139]
    ds_read_b64_tr_b16 v[112:113], v17 offset:53248
    ds_read_b64_tr_b16 v[114:115], v17 offset:54272
    s_waitcnt lgkmcnt(10)
    v_mfma_f32_16x16x32_bf16 v[140:143], v[92:95], v[68:71], v[140:143]
    ds_read_b64_tr_b16 v[116:117], v14 offset:57344
    ds_read_b64_tr_b16 v[118:119], v14 offset:58368
    s_waitcnt lgkmcnt(10)
    v_mfma_f32_16x16x32_bf16 v[144:147], v[96:99], v[68:71], v[144:147]
    ds_read_b64_tr_b16 v[120:121], v15 offset:57344
    ds_read_b64_tr_b16 v[122:123], v15 offset:58368
    s_waitcnt lgkmcnt(10)
    v_mfma_f32_16x16x32_bf16 v[132:135], v[100:103], v[72:75], v[132:135]
    ds_read_b64_tr_b16 v[124:125], v16 offset:57344
    ds_read_b64_tr_b16 v[126:127], v16 offset:58368
    s_waitcnt lgkmcnt(10)
    v_mfma_f32_16x16x32_bf16 v[136:139], v[104:107], v[72:75], v[136:139]
    ds_read_b64_tr_b16 v[128:129], v17 offset:57344
    ds_read_b64_tr_b16 v[130:131], v17 offset:58368
    s_waitcnt lgkmcnt(10)
    v_mfma_f32_16x16x32_bf16 v[140:143], v[108:111], v[72:75], v[140:143]
    ds_read_b64_tr_b16 v[84:85], v14 offset:61440
    ds_read_b64_tr_b16 v[86:87], v14 offset:62464
    s_waitcnt lgkmcnt(10)
    v_mfma_f32_16x16x32_bf16 v[144:147], v[112:115], v[72:75], v[144:147]
    ds_read_b64_tr_b16 v[88:89], v15 offset:61440
    ds_read_b64_tr_b16 v[90:91], v15 offset:62464
    s_waitcnt lgkmcnt(10)
    v_mfma_f32_16x16x32_bf16 v[132:135], v[116:119], v[76:79], v[132:135]
    ds_read_b64_tr_b16 v[92:93], v16 offset:61440
    ds_read_b64_tr_b16 v[94:95], v16 offset:62464
    s_waitcnt lgkmcnt(10)
    v_mfma_f32_16x16x32_bf16 v[136:139], v[120:123], v[76:79], v[136:139]
    ds_read_b64_tr_b16 v[96:97], v17 offset:61440
    ds_read_b64_tr_b16 v[98:99], v17 offset:62464
    s_waitcnt lgkmcnt(10)
    v_mfma_f32_16x16x32_bf16 v[140:143], v[124:127], v[76:79], v[140:143]
    s_waitcnt lgkmcnt(8)
    v_mfma_f32_16x16x32_bf16 v[144:147], v[128:131], v[76:79], v[144:147]
    s_waitcnt lgkmcnt(6)
    v_mfma_f32_16x16x32_bf16 v[132:135], v[84:87], v[80:83], v[132:135]
    s_waitcnt lgkmcnt(4)
    v_mfma_f32_16x16x32_bf16 v[136:139], v[88:91], v[80:83], v[136:139]
    s_waitcnt lgkmcnt(2)
    v_mfma_f32_16x16x32_bf16 v[140:143], v[92:95], v[80:83], v[140:143]
    s_waitcnt lgkmcnt(0)
    v_mfma_f32_16x16x32_bf16 v[144:147], v[96:99], v[80:83], v[144:147]
    s_nop 7
    v_cvt_pk_bf16_f32 v132, v132, v133
    v_cvt_pk_bf16_f32 v133, v134, v135
    buffer_store_dwordx2 v[132:133], v18, s[56:59], s73 offen offset:0
    v_cvt_pk_bf16_f32 v136, v136, v137
    v_cvt_pk_bf16_f32 v137, v138, v139
    buffer_store_dwordx2 v[136:137], v18, s[56:59], s73 offen offset:32
    v_cvt_pk_bf16_f32 v140, v140, v141
    v_cvt_pk_bf16_f32 v141, v142, v143
    buffer_store_dwordx2 v[140:141], v18, s[56:59], s73 offen offset:64
    v_cvt_pk_bf16_f32 v144, v144, v145
    v_cvt_pk_bf16_f32 v145, v146, v147
    buffer_store_dwordx2 v[144:145], v18, s[56:59], s73 offen offset:96
L_end:
    s_endpgm
L_codeend:
.section .rodata,"a"
.p2align 6
.amdhsa_kernel concat_heads__sliding_local_dilated__softmax_full_mha__prompt_kernel
  .amdhsa_next_free_vgpr 168
  .amdhsa_next_free_sgpr 102
  .amdhsa_accum_offset 168
  .amdhsa_group_segment_fixed_size 0
  .amdhsa_kernarg_size 72
  .amdhsa_user_sgpr_count 2
  .amdhsa_user_sgpr_kernarg_segment_ptr 1
  .amdhsa_system_sgpr_workgroup_id_x 1
.end_amdhsa_kernel
```
